```python
import torch

def _softmax(x, axis=-1):
    return torch.softmax(x, dim=axis)
def _gelu(x):
    return torch.nn.functional.gelu(x, approximate="tanh")
def _silu(x):
    return torch.nn.functional.silu(x)
def _sigmoid(x):
    return torch.sigmoid(x)
def _layernorm(x, axis=-1, eps=1e-5):
    m = x.mean(dim=axis, keepdim=True)
    v = x.var(dim=axis, keepdim=True, unbiased=False)
    return (x - m) / torch.sqrt(v + eps)
def _scatter_add(tgt, idx, src, axis=0):
    return tgt.clone().index_add_(axis, idx, src)
def _segment_sum(src, seg, n):
    out = torch.zeros((n,) + src.shape[1:], dtype=src.dtype)
    return out.index_add_(0, seg, src)
def _pad(x, pw):
    flat = tuple(v for pair in reversed(pw) for v in pair)
    return torch.nn.functional.pad(x, flat)

kernel_name = 'gather_scatter__hybrid_graph_tf_nagphormer__graph'

def setup_inputs():

    _w = (lambda a: (lambda t: t.to(torch.bfloat16) if t.is_floating_point() else t)(torch.as_tensor(a)))
    N, deg, D = 10000, 32, 128
    E = N * deg
    src = (lambda lo, hi, *s: torch.randint(lo, hi, s))(0, N, E).to(torch.int64)
    dst = (lambda lo, hi, *s: torch.randint(lo, hi, s))(0, N, E).to(torch.int64)
    deg_cnt = torch.bincount(dst, minlength=N).to(float) + 1.0
    sc = 1.0 / D ** 0.5
    return {
        "x": _w((lambda *s: torch.randn(*s, dtype=torch.bfloat16) * 0.1)(N, D)),
        "src": _w(src),
        "dst": _w(dst),
        "deg_inv_sqrt": _w(1.0 / (lambda _x: torch.sqrt(torch.as_tensor(_x)))(deg_cnt)),
        "wq": _w((lambda *s: torch.randn(*s, dtype=torch.bfloat16) * 1.6)(D, D) * sc),
        "wk": _w((lambda *s: torch.randn(*s, dtype=torch.bfloat16) * 1.6)(D, D) * sc),
        "wv": _w((lambda *s: torch.randn(*s, dtype=torch.bfloat16) * 0.1)(D, D) * sc),
        "wo": _w((lambda *s: torch.randn(*s, dtype=torch.bfloat16) * 0.1)(D, D) * sc),
        "w_r": _w((lambda *s: torch.randn(*s, dtype=torch.bfloat16) * 0.1)(D)),
    }

def reference(x, src, dst, deg_inv_sqrt, wq, wk, wv, wo, w_r):
    N, D = x.shape[0], x.shape[1]
    K = 7
    h = x
    toks = [x]
    for _ in range(K):
        msg = h[src] * deg_inv_sqrt[src, None] * deg_inv_sqrt[dst, None]
        h = _segment_sum(msg, dst, N)
        toks.append(h)
    tok = torch.stack(toks, axis=1)
    t = _layernorm(tok, axis=-1)
    q   = torch.einsum('nkd,de->nke', t, wq)
    key = torch.einsum('nkd,de->nke', t, wk)
    v   = torch.einsum('nkd,de->nke', t, wv)
    scale = 1.0 / (D ** 0.5)
    attn = _softmax(torch.einsum('nkd,nld->nkl', q, key) * scale, axis=-1)
    o = torch.einsum('nkl,nld->nkd', attn, v)
    o = tok + torch.einsum('nkd,de->nke', o, wo)
    r = _layernorm(o, axis=-1)
    alpha = _softmax(torch.einsum('nkd,d->nk', r, w_r), axis=-1)
    return torch.einsum('nk,nkd->nd', alpha, o)
```

```asm
; @launch grid=(256,1,1) block=(1024,1,1) lds=163840
.amdgcn_target "amdgcn-amd-amdhsa--gfx950"
.text
.globl gather_scatter__hybrid_graph_tf_nagphormer__graph_kernel
.p2align 8
.type gather_scatter__hybrid_graph_tf_nagphormer__graph_kernel,@function
gather_scatter__hybrid_graph_tf_nagphormer__graph_kernel:
    s_cmp_ge_u32 s2, 256
    s_cbranch_scc1 km_end
    s_load_dwordx8 s[60:67], s[0:1], 64
    s_load_dwordx8 s[44:51], s[0:1], 0
    v_lshrrev_b32 v1, 6, v0
    s_getreg_b32 s77, hwreg(HW_REG_XCC_ID, 0, 4)
    s_lshr_b32 s76, s2, 3
    v_readfirstlane_b32 s14, v1
    v_and_b32 v1, 63, v0
    s_and_b32 s78, s77, 7
    s_lshl_b32 s78, s78, 5
    s_and_b32 s6, s2, 7
    s_mul_i32 s6, s6, 20
    s_add_u32 s6, s6, s76
    s_or_b32 s76, s76, s78
    s_mov_b32 s84, 0
    s_add_u32 s86, s14, 4
    s_bfe_u32 s86, s86, 0x10003
    s_mov_b32 s70, 2560000
    s_mov_b32 s71, 0x20000
    s_mov_b32 s74, 20000
    s_mov_b32 s75, 0x20000
    v_mov_b32 v113, 0
    v_mov_b32 v66, 0
    v_mov_b32 v67, 0
    v_mov_b32 v2, 122560
    ds_write_b64 v2, v[66:67]
    v_mov_b32 v127, 0
    s_waitcnt lgkmcnt(0)
    s_mov_b64 s[4:5], s[66:67]
    s_mov_b64 s[68:69], s[44:45]
    s_mov_b64 s[72:73], s[50:51]
    s_mov_b64 s[60:61], s[44:45]
    s_load_dword s91, s[4:5], 268288
    s_cmp_lg_u32 s14, 15
    s_cbranch_scc1 km_nl
    s_lshr_b32 s78, s76, 3
    s_lshl_b32 s78, s78, 7
    s_add_u32 s78, s78, 258048
    v_and_b32 v113, 7, v1
    v_lshl_add_u32 v113, v113, 2, s78
    global_load_dword v112, v113, s[4:5] sc1
km_nl:
    s_cmp_lt_u32 s2, 176
    s_cbranch_scc1 km_nosort
    s_sub_u32 s24, s2, 176
    s_mul_i32 s15, s24, 16000
    v_lshl_add_u32 v2, v0, 4, s15
    s_cmp_eq_u32 s14, 15
    s_cselect_b32 s23, 0xff, -1
    s_mov_b32 s22, -1
    s_mov_b64 exec, s[22:23]
    global_load_dwordx4 v[4:7], v2, s[48:49]
    global_load_dwordx4 v[8:11], v2, s[46:47]
    s_add_u32 s18, s4, 327680
    s_addc_u32 s19, s5, 0
    v_mov_b32 v28, -1
    v_mov_b32 v29, -1
    v_mov_b32 v30, -1
    v_mov_b32 v31, -1
    s_mov_b64 exec, -1
    v_mov_b32 v24, 0
    v_and_b32 v3, 255, v0
    v_lshlrev_b32 v3, 2, v3
    ds_write_b32 v3, v24 offset:40960
    v_lshlrev_b32 v26, 4, v1
    v_lshlrev_b32 v3, 4, v0
    s_mul_i32 s15, s24, 1280
    s_add_u32 s15, s15, 0
    s_add_u32 s16, s4, s15
    s_addc_u32 s17, s5, 0
    v_mov_b32 v24, 1
    v_mov_b32 v25, 5120
    s_waitcnt lgkmcnt(0)
    s_mul_i32 s90, s91, 0x9e3779b1
    s_add_u32 s90, s90, 0x7f4a7c15
    s_barrier
    s_mov_b64 exec, s[22:23]
    s_waitcnt vmcnt(1)
    v_bfe_u32 v16, v4, 6, 8
    v_lshlrev_b32 v16, 2, v16
    ds_add_rtn_u32 v12, v16, v24 offset:40960
    v_bfe_u32 v17, v5, 6, 8
    v_lshlrev_b32 v17, 2, v17
    ds_add_rtn_u32 v13, v17, v24 offset:40960
    v_bfe_u32 v18, v6, 6, 8
    v_lshlrev_b32 v18, 2, v18
    ds_add_rtn_u32 v14, v18, v24 offset:40960
    v_bfe_u32 v19, v7, 6, 8
    v_lshlrev_b32 v19, 2, v19
    ds_add_rtn_u32 v15, v19, v24 offset:40960
    s_waitcnt vmcnt(0)
    s_mov_b64 exec, -1
    s_cmp_lg_u32 s14, 15
    s_cbranch_scc1 km_c2s
    s_waitcnt vmcnt(0)
    s_getpc_b64 s[82:83]
    s_branch km_pick
km_c2s:
    s_mov_b64 exec, s[22:23]
    v_cmp_ge_u32 s[20:21], v8, v25
    v_sub_u32 v20, v8, v4
    v_and_b32 v20, 31, v20
    v_cndmask_b32 v21, 0, v25, s[20:21]
    v_lshlrev_b32 v4, 26, v4
    v_add_u32 v8, v8, v21
    v_lshl_or_b32 v4, v20, 16, v4
    v_and_b32 v8, 0x3fff, v8
    v_or_b32 v8, v8, v4
    v_cmp_ge_u32 s[20:21], v9, v25
    v_sub_u32 v20, v9, v5
    v_and_b32 v20, 31, v20
    v_cndmask_b32 v21, 0, v25, s[20:21]
    v_lshlrev_b32 v5, 26, v5
    v_add_u32 v9, v9, v21
    v_lshl_or_b32 v5, v20, 16, v5
    v_and_b32 v9, 0x3fff, v9
    v_or_b32 v9, v9, v5
    v_cmp_ge_u32 s[20:21], v10, v25
    v_sub_u32 v20, v10, v6
    v_and_b32 v20, 31, v20
    v_cndmask_b32 v21, 0, v25, s[20:21]
    v_lshlrev_b32 v6, 26, v6
    v_add_u32 v10, v10, v21
    v_lshl_or_b32 v6, v20, 16, v6
    v_and_b32 v10, 0x3fff, v10
    v_or_b32 v10, v10, v6
    v_cmp_ge_u32 s[20:21], v11, v25
    v_sub_u32 v20, v11, v7
    v_and_b32 v20, 31, v20
    v_cndmask_b32 v21, 0, v25, s[20:21]
    v_lshlrev_b32 v7, 26, v7
    v_add_u32 v11, v11, v21
    v_lshl_or_b32 v7, v20, 16, v7
    v_and_b32 v11, 0x3fff, v11
    v_or_b32 v11, v11, v7
    s_mov_b64 exec, -1
    s_waitcnt lgkmcnt(0)
    s_barrier
    ds_read_b128 v[20:23], v26 offset:40960
    s_waitcnt lgkmcnt(0)
    v_add3_u32 v24, v20, v21, v22
    v_add_u32 v24, v24, v23
    v_mov_b32 v25, v24
    s_nop 0
    v_add_u32_dpp v24, v24, v24 row_shr:1 row_mask:0xf bank_mask:0xf
    s_nop 1
    v_add_u32_dpp v24, v24, v24 row_shr:2 row_mask:0xf bank_mask:0xf
    s_nop 1
    v_add_u32_dpp v24, v24, v24 row_shr:4 row_mask:0xf bank_mask:0xf
    s_nop 1
    v_add_u32_dpp v24, v24, v24 row_shr:8 row_mask:0xf bank_mask:0xf
    s_nop 1
    v_add_u32_dpp v24, v24, v24 row_bcast:15 row_mask:0xa bank_mask:0xf
    s_nop 1
    v_add_u32_dpp v24, v24, v24 row_bcast:31 row_mask:0xc bank_mask:0xf
    v_sub_u32 v4, v24, v25
    v_add_u32 v5, v4, v20
    v_add_u32 v6, v5, v21
    v_add_u32 v7, v6, v22
    ds_write_b128 v26, v[4:7] offset:41984
    s_mov_b64 exec, s[22:23]
    ds_read_b32 v16, v16 offset:41984
    ds_read_b32 v17, v17 offset:41984
    ds_read_b32 v18, v18 offset:41984
    ds_read_b32 v19, v19 offset:41984
    s_waitcnt lgkmcnt(0)
    v_add_lshl_u32 v16, v16, v12, 2
    ds_write_b32 v16, v8 offset:43008
    v_add_lshl_u32 v17, v17, v13, 2
    ds_write_b32 v17, v9 offset:43008
    v_add_lshl_u32 v18, v18, v14, 2
    ds_write_b32 v18, v10 offset:43008
    v_add_lshl_u32 v19, v19, v15, 2
    ds_write_b32 v19, v11 offset:43008
    s_waitcnt lgkmcnt(0)
    s_barrier
    ds_read_b128 v[8:11], v3 offset:43008
    s_waitcnt lgkmcnt(0)
    global_store_dwordx4 v2, v[8:11], s[18:19] sc1
    v_lshl_or_b32 v28, v20, 16, v4
    v_mov_b32 v29, s90
    v_lshl_or_b32 v30, v21, 16, v5
    v_mov_b32 v31, s90
    v_lshl_or_b32 v32, v22, 16, v6
    v_mov_b32 v33, s90
    v_lshl_or_b32 v34, v23, 16, v7
    v_mov_b32 v35, s90
    v_lshlrev_b32 v26, 5, v1
    s_cmp_lg_u32 s14, 15
    s_waitcnt vmcnt(0)
    s_barrier
    s_cbranch_scc1 kmb_done
    global_store_dwordx4 v26, v[28:31], s[16:17] sc1
    global_store_dwordx4 v26, v[32:35], s[16:17] offset:16 sc1
kmb_done:
    s_mov_b64 exec, -1
    s_branch km_c2x
km_nosort:
    s_and_b32 s78, s2, 0xfe
    s_cmp_eq_u32 s78, 160
    s_cbranch_scc1 kms_weights
    s_cmp_ge_u32 s14, 2
    s_cselect_b32 s78, -1, 0
    v_mov_b32 v12, s78
    v_mov_b32 v13, s78
    v_mov_b32 v14, s78
    v_mov_b32 v15, s78
    s_cmp_ge_u32 s2, 160
    s_cbranch_scc1 km_ni
    s_cmp_ge_u32 s14, 11
    s_cbranch_scc1 km_mk
    v_lshlrev_b32 v16, 4, v0
    ds_write_b128 v16, v[12:15] offset:40960
    s_branch km_i2
    km_mk:
    s_branch km_i2
km_ni:
    s_cmp_lt_u32 s2, 168
    s_cbranch_scc1 km_ct
    s_cmp_eq_u32 s14, 15
    s_cbranch_scc1 km_i2
    s_getpc_b64 s[82:83]
km_pc0:
    v_lshlrev_b32 v16, 7, v0
    v_cmp_gt_u32 vcc, (code_end-km_pc0)/128, v0
    s_and_b64 exec, exec, vcc
    s_cbranch_execz km_pf1
    global_load_dword v17, v16, s[82:83]
km_pf1:
    s_mov_b64 exec, -1
    s_cmp_lg_u32 s14, 14
    s_cbranch_scc1 km_i2
    v_lshlrev_b32 v16, 21, v1
    s_mov_b64 exec, 0xffff
    global_load_dword v17, v16, s[4:5]
    s_mov_b64 exec, 3
    global_load_dword v18, v16, s[62:63]
    s_mov_b64 exec, -1
km_i2:
    s_waitcnt lgkmcnt(0)
    s_mul_i32 s90, s91, 0x9e3779b1
    s_add_u32 s90, s90, 0x7f4a7c15
km_common:
    s_cmp_ge_u32 s2, 160
    s_cbranch_scc1 km_eb
    s_barrier
km_eb:
    s_cmp_lg_u32 s14, 15
    s_cbranch_scc1 km_c2x
    s_waitcnt vmcnt(0)
    s_getpc_b64 s[82:83]
    s_branch km_pick
km_c2x:
    s_cmp_ge_u32 s2, 160
    s_cbranch_scc1 km_gl
    s_cmp_ge_u32 s14, 8
    s_cbranch_scc1 km_sl0
    s_lshl_b32 s78, s2, 5
    v_and_b32 v66, 31, v1
    v_add_u32 v66, s78, v66
    v_lshrrev_b32 v68, 5, v0
    v_lshlrev_b32 v67, 9, v66
    v_lshl_add_u32 v67, v68, 4, v67
    buffer_load_dwordx4 v[48:51], v67, s[68:71], 0 offen
    buffer_load_dwordx4 v[52:55], v67, s[68:71], 0 offen offset:256
    v_lshlrev_b32 v67, 2, v66
    buffer_load_dword v64, v67, s[72:75], 0 offen
    v_mul_u32_u24 v68, 163840, v68
    v_lshl_add_u32 v66, v66, 4, v68
    v_add_u32 v66, 4194304, v66
    v_add_u32 v67, 81920, v66
    s_waitcnt vmcnt(0)
    v_and_b32 v65, 0xffff0000, v64
    v_lshlrev_b32 v64, 16, v64
    v_lshlrev_b32 v68, 16, v48
    v_and_b32 v69, 0xffff0000, v48
    v_mul_f32 v68, v68, v64
    v_mul_f32 v69, v69, v64
    v_cvt_pk_bf16_f32 v56, v68, v69
    v_lshlrev_b32 v68, 16, v49
    v_and_b32 v69, 0xffff0000, v49
    v_mul_f32 v68, v68, v64
    v_mul_f32 v69, v69, v64
    v_cvt_pk_bf16_f32 v57, v68, v69
    v_lshlrev_b32 v68, 16, v50
    v_and_b32 v69, 0xffff0000, v50
    v_mul_f32 v68, v68, v64
    v_mul_f32 v69, v69, v64
    v_cvt_pk_bf16_f32 v60, v68, v69
    v_lshlrev_b32 v68, 16, v51
    v_and_b32 v69, 0xffff0000, v51
    v_mul_f32 v68, v68, v64
    v_mul_f32 v69, v69, v64
    v_cvt_pk_bf16_f32 v61, v68, v69
    v_lshlrev_b32 v68, 16, v52
    v_and_b32 v69, 0xffff0000, v52
    v_mul_f32 v68, v68, v65
    v_mul_f32 v69, v69, v65
    v_cvt_pk_bf16_f32 v58, v68, v69
    v_lshlrev_b32 v68, 16, v53
    v_and_b32 v69, 0xffff0000, v53
    v_mul_f32 v68, v68, v65
    v_mul_f32 v69, v69, v65
    v_cvt_pk_bf16_f32 v59, v68, v69
    v_lshlrev_b32 v68, 16, v54
    v_and_b32 v69, 0xffff0000, v54
    v_mul_f32 v68, v68, v65
    v_mul_f32 v69, v69, v65
    v_cvt_pk_bf16_f32 v62, v68, v69
    v_lshlrev_b32 v68, 16, v55
    v_and_b32 v69, 0xffff0000, v55
    v_mul_f32 v68, v68, v65
    v_mul_f32 v69, v69, v65
    v_cvt_pk_bf16_f32 v63, v68, v69
km_sl0:
    s_cmp_ge_u32 s14, 8
    s_cbranch_scc1 km_sl1
    global_store_dwordx4 v66, v[56:59], s[4:5] sc1
    global_store_dwordx4 v67, v[60:63], s[4:5] sc1
    v_mov_b32 v68, 42268
    v_mov_b32 v69, 1
    s_lshl_b32 s78, s2, 7
    s_add_u32 s78, s78, 131072
    s_mov_b64 exec, 1
    s_waitcnt vmcnt(0)
    ds_add_rtn_u32 v68, v68, v69
    v_mov_b32 v48, s78
    v_mov_b32 v49, s90
    s_waitcnt lgkmcnt(0)
    v_cmp_eq_u32 vcc, 7, v68
    s_cbranch_vccz km_sl2
    global_store_dword v48, v49, s[4:5] sc1
km_sl2:
    s_mov_b64 exec, -1
km_sl1:
km_gl:
    s_cmp_lg_u32 s14, 15
    s_cbranch_scc1 km_c3dx
    s_branch km_c3bx
km_c3ax:
    s_getpc_b64 s[82:83]
    s_branch km_relook
km_c3bx:
    s_waitcnt vmcnt(0)
    v_cmp_ne_u32 vcc, v116, v115
    s_cbranch_vccnz km_c3ax
    global_load_dword v112, v113, s[4:5] sc1
km_c3dx:
    s_cmp_ge_u32 s2, 160
    s_cbranch_scc1 kms_other
    v_mul_u32_u24 v2, 5462, v0
    v_lshrrev_b32 v2, 16, v2
    v_mul_u32_u24 v3, 12, v2
    v_sub_u32 v3, v0, v3
    s_lshr_b32 s18, s2, 3
    v_mul_u32_u24 v33, 1280, v2
    s_lshl_b32 s47, s6, 3
    s_mov_b32 s10, 102400
    s_mov_b32 s11, 0x20000
    s_movk_i32 s15, 80
    v_cmp_gt_u32 s[36:37], s15, v2
    v_mul_u32_u24 v2, 4000, v2
    s_add_u32 s8, s4, 0
    s_addc_u32 s9, s5, 0
    s_add_u32 s12, s4, 327680
    s_addc_u32 s13, s5, 0
    v_add_u32 v2, v2, v3
    v_mov_b32 v34, 1
    s_mov_b32 s19, 0x43fd
    s_mov_b32 s46, 0x7c
    s_lshr_b32 s45, 0xc3, s18
    s_and_b32 s45, s45, 1
    s_add_u32 s44, s45, 1
    v_lshrrev_b32 v37, 5, v1
    v_mul_u32_u24 v38, 0x020202, v37
    v_lshl_or_b32 v38, v37, 25, v38
    v_add_u32 v38, 0x05040100, v38
    v_and_b32 v37, s45, v37
    s_lshl_b32 s15, s14, 3
    s_lshl_b32 s16, s15, s45
    s_and_b32 s16, s16, 63
    v_add_u32 v37, s16, v37
    s_lshl_b32 s17, s45, 5
    v_mov_b32 v29, s15
    v_bfi_b32 v29, s17, v29, v1
    s_and_b32 s17, s16, 32
    s_lshl_b32 s17, s17, 3
    v_lshl_add_u32 v36, v29, 2, s17
    v_mul_u32_u24 v35, 144, v29
    s_lshl_b32 s16, s16, 1
    v_add_u32 v35, s16, v35
    s_lshl_b32 s15, s6, 13
    s_lshl_b32 s16, s14, 10
    s_add_u32 s15, s15, s16
    s_add_u32 s15, s15, 2097152
    s_add_u32 s42, s4, s15
    s_addc_u32 s43, s5, 0
    v_lshlrev_b32 v39, 4, v1
    s_cmp_lg_u32 s14, 8
    s_cbranch_scc1 kms_og
    s_lshr_b32 s15, s2, 1
    s_mul_i32 s15, s15, 1280
    v_mov_b32 v29, s15
    kms_oq:
    buffer_load_dwordx2 v[40:41], v29, s[8:11], s47 offen sc1
    s_waitcnt vmcnt(0)
    v_cmp_ne_u32 vcc, s90, v41
    s_cbranch_vccz kms_og
    s_sleep 6
    s_branch kms_oq
kms_og:
    s_barrier
    kms_op:
    buffer_load_dwordx2 v[40:41], v33, s[8:11], s47 offen sc1
    s_waitcnt vmcnt(0)
    v_cmp_ne_u32 vcc, s90, v41
    s_and_b64 vcc, vcc, s[36:37]
    s_cbranch_scc0 kms_od
    s_sleep 2
    s_branch kms_op
kms_od:
    v_add_u32_sdwa v2, v2, v40 dst_sel:DWORD dst_unused:UNUSED_PAD src0_sel:DWORD src1_sel:WORD_0
    v_sub_u32_sdwa v31, v40, v3 dst_sel:DWORD dst_unused:UNUSED_PAD src0_sel:WORD_1 src1_sel:DWORD
    v_lshlrev_b32 v32, 2, v2
    v_cmp_lt_i32 s[20:21], 0, v31
    v_cmp_lt_i32 s[22:23], 12, v31
    v_cmp_lt_i32 s[24:25], 24, v31
    v_cmp_lt_i32 s[26:27], 36, v31
    v_cmp_lt_i32 s[28:29], 48, v31
    v_cmp_lt_i32 vcc, 60, v31
    global_load_dword v4, v32, s[12:13] offset:0 sc1
    global_load_dword v5, v32, s[12:13] offset:48 sc1
    s_or_b64 exec, s[24:25], 1
    global_load_dword v6, v32, s[12:13] offset:96 sc1
    s_or_b64 exec, s[26:27], 1
    global_load_dword v7, v32, s[12:13] offset:144 sc1
    s_or_b64 exec, s[28:29], 1
    global_load_dword v8, v32, s[12:13] offset:192 sc1
    s_mov_b64 exec, -1
    s_cmp_lg_u32 s14, 15
    s_cbranch_scc1 km_rpa
    s_mov_b64 s[82:83], vcc
    s_waitcnt vmcnt(5)
km_rqa:
    v_subrev_u32 v114, s90, v112
    v_cmp_lt_u32 vcc, 1, v114
    s_cbranch_vccnz km_rwa
    v_cmp_ne_u32 vcc, 0, v114
    s_and_b32 s78, vcc_lo, 0xff
    s_lshl_b32 s78, s78, 9
    s_or_b32 s78, s78, s76
    v_mov_b32 v112, 77816
    v_mov_b32 v114, s78
    ds_write_b32 v112, v114
    s_mov_b64 vcc, s[82:83]
km_rpa:
    s_waitcnt lgkmcnt(0)
    s_barrier
    s_cbranch_vccz kms_nomore
    s_mov_b64 exec, vcc
    v_mov_b32 v29, 42260
    ds_write_b32 v29, v34
    s_mov_b64 exec, -1
kms_nomore:
    s_mov_b32 s41, 0
    v_mov_b32 v112, 77816
    ds_read_b32 v112, v112
    s_waitcnt lgkmcnt(0)
    v_readfirstlane_b32 s78, v112
    s_and_b32 s76, s78, 255
    s_lshr_b32 s85, s78, 9
    s_cmp_eq_u32 s14, 15
    s_cbranch_scc1 km_t1
km_t1r:
    s_waitcnt vmcnt(4)
    v_lshrrev_b32 v19, 24, v4
    v_lshlrev_b32_sdwa v9, v4, v34 dst_sel:DWORD dst_unused:UNUSED_PAD src0_sel:WORD_1 src1_sel:DWORD
    s_mov_b64 exec, s[20:21]
    ds_or_rtn_b32 v14, v19, v9 offset:40960
    s_mov_b64 exec, -1
    s_waitcnt vmcnt(3)
    v_lshrrev_b32 v20, 24, v5
    v_lshlrev_b32_sdwa v10, v5, v34 dst_sel:DWORD dst_unused:UNUSED_PAD src0_sel:WORD_1 src1_sel:DWORD
    s_mov_b64 exec, s[22:23]
    ds_or_rtn_b32 v15, v20, v10 offset:40960
    s_mov_b64 exec, -1
    s_waitcnt vmcnt(2)
    v_lshrrev_b32 v21, 24, v6
    v_lshlrev_b32_sdwa v11, v6, v34 dst_sel:DWORD dst_unused:UNUSED_PAD src0_sel:WORD_1 src1_sel:DWORD
    s_mov_b64 exec, s[24:25]
    ds_or_rtn_b32 v16, v21, v11 offset:40960
    s_mov_b64 exec, -1
    v_bfe_u32 v24, v4, 15, 6
    v_lshlrev_b32 v29, 2, v4
    v_mad_u32_u24 v24, v19, 36, v24
    v_bfi_b32 v19, s46, v29, v19
    v_bfe_u32 v25, v5, 15, 6
    v_lshlrev_b32 v29, 2, v5
    v_mad_u32_u24 v25, v20, 36, v25
    v_bfi_b32 v20, s46, v29, v20
    v_bfe_u32 v26, v6, 15, 6
    v_lshlrev_b32 v29, 2, v6
    v_mad_u32_u24 v26, v21, 36, v26
    v_bfi_b32 v21, s46, v29, v21
    s_waitcnt vmcnt(0) lgkmcnt(0)
    v_and_b32 v14, v14, v9
    v_cmp_eq_u32 vcc, 0, v14
    s_and_b64 exec, vcc, s[20:21]
    ds_or_b32 v19, v9 offset:41472
    ds_write_b16 v24, v4 offset:43008
    s_andn2_b64 s[20:21], s[20:21], vcc
    s_mov_b64 exec, -1
    v_and_b32 v15, v15, v10
    v_cmp_eq_u32 vcc, 0, v15
    s_and_b64 exec, vcc, s[22:23]
    ds_or_b32 v20, v10 offset:41472
    ds_write_b16 v25, v5 offset:43008
    s_andn2_b64 s[22:23], s[22:23], vcc
    s_mov_b64 exec, -1
    v_and_b32 v16, v16, v11
    v_cmp_eq_u32 vcc, 0, v16
    s_and_b64 exec, vcc, s[24:25]
    ds_or_b32 v21, v11 offset:41472
    ds_write_b16 v26, v6 offset:43008
    s_andn2_b64 s[24:25], s[24:25], vcc
    s_mov_b64 exec, -1
kms_append:
    s_bcnt1_i32_b64 s15, s[20:21]
    s_bcnt1_i32_b64 s16, s[22:23]
    s_bcnt1_i32_b64 s17, s[24:25]
    s_bcnt1_i32_b64 s18, s[26:27]
    s_bcnt1_i32_b64 s38, s[28:29]
    s_add_u32 s16, s16, s15
    s_add_u32 s17, s17, s16
    s_add_u32 s18, s18, s17
    s_add_u32 s38, s38, s18
    v_mov_b32 v29, 42256
    v_mov_b32 v30, s38
    s_mov_b64 exec, 1
    ds_add_rtn_u32 v30, v29, v30
    s_mov_b64 exec, -1
    v_mbcnt_lo_u32_b32 v24, s20, 0
    v_mbcnt_hi_u32_b32 v24, s21, v24
    v_mbcnt_lo_u32_b32 v25, s22, 0
    v_mbcnt_hi_u32_b32 v25, s23, v25
    v_mbcnt_lo_u32_b32 v26, s24, 0
    v_mbcnt_hi_u32_b32 v26, s25, v26
    s_waitcnt lgkmcnt(0)
    v_readfirstlane_b32 s38, v30
    s_add_u32 s15, s15, s38
    s_add_u32 s16, s16, s38
    s_add_u32 s17, s17, s38
    s_add_u32 s18, s18, s38
    s_mov_b64 exec, s[20:21]
    v_add_lshl_u32 v24, v24, s38, 2
    ds_write_b32 v24, v4 offset:52224
    s_mov_b64 exec, s[22:23]
    v_add_lshl_u32 v25, v25, s15, 2
    ds_write_b32 v25, v5 offset:52224
    s_mov_b64 exec, s[24:25]
    v_add_lshl_u32 v26, v26, s16, 2
    ds_write_b32 v26, v6 offset:52224
    s_mov_b64 exec, s[26:27]
    s_cbranch_execz kms_appd
    v_mbcnt_lo_u32_b32 v27, s26, 0
    v_mbcnt_hi_u32_b32 v27, s27, v27
    v_add_lshl_u32 v27, v27, s17, 2
    ds_write_b32 v27, v7 offset:52224
    s_mov_b64 exec, s[28:29]
    s_cbranch_execz kms_appd
    v_mbcnt_lo_u32_b32 v28, s28, 0
    v_mbcnt_hi_u32_b32 v28, s29, v28
    v_add_lshl_u32 v28, v28, s18, 2
    ds_write_b32 v28, v8 offset:52224
kms_appd:
    s_mov_b64 exec, -1
    v_lshlrev_b32 v29, 2, v0
    v_mov_b32 v30, 42256
    s_lshl_b32 s40, s14, 6
    s_waitcnt lgkmcnt(0)
    s_barrier
    ds_read_b32 v4, v29 offset:52224
    ds_read_b64 v[8:9], v30
    s_cmp_lg_u32 s41, 0
    s_cbranch_scc1 kms_nosd
kms_nosd:
    s_waitcnt lgkmcnt(0)
    v_readfirstlane_b32 s47, v8
    v_readfirstlane_b32 s41, v9
    s_cmp_ge_u32 s40, s47
    s_cbranch_scc1 kms_rdone
kms_have:
    v_lshrrev_b32 v5, 24, v4
    v_lshlrev_b32 v6, 2, v4
    v_add_u32 v29, s40, v1
    v_bfi_b32 v6, s46, v6, v5
    v_cmp_gt_u32 vcc, s47, v29
    v_mul_u32_u24 v7, 0x9e3779, v29
    v_mov_b32 v23, 0xfff
    s_mov_b64 s[36:37], vcc
    s_mov_b64 exec, vcc
    s_mov_b32 s48, 3
kms_round:
    ds_read2st64_b32 v[8:9], v5 offset0:160 offset1:161
    ds_read2st64_b32 v[10:11], v6 offset0:162 offset1:163
    v_mad_u32_u24 v7, v7, s19, v4
    v_bfe_u32 v14, v7, 14, 5
    v_bfe_i32 v18, v7, 19, 1
    v_mul_u32_u24 v15, 12, v14
    v_lshrrev_b32 v15, 5, v15
    s_sub_u32 s48, s48, 1
    s_waitcnt lgkmcnt(0)
    v_bitop3_b32 v16, v8, v10, v18 bitop3:0x02
    v_bitop3_b32 v9, v9, v11, v23 bitop3:0x02
    v_cmp_eq_u32 s[38:39], 0, v16
    v_bitop3_b32 v8, v8, v10, v10 bitop3:0x03
    s_nop 0
    v_cndmask_b32 v16, 0, v9, s[38:39]
    v_cmp_ne_u32 s[38:39], 0, v16
    s_nop 1
    v_cndmask_b32 v13, v8, v9, s[38:39]
    v_cndmask_b32 v14, v14, v15, s[38:39]
    v_cndmask_b32 v16, 0, 32, s[38:39]
    v_alignbit_b32 v15, v13, v13, v14
    v_min_u32 v13, 1, v13
    v_ffbl_b32 v15, v15
    v_lshl_add_u32 v21, v16, 3, v5
    v_add_u32 v15, v15, v14
    v_lshl_add_u32 v22, v16, 3, v6
    v_lshlrev_b32 v12, v15, v13
    ds_or_rtn_b32 v19, v21, v12 offset:40960
    ds_or_rtn_b32 v20, v22, v12 offset:41472
    v_and_or_b32 v17, v15, 31, v16
    s_waitcnt lgkmcnt(0)
    v_bitop3_b32 v24, v19, v20, v12 bitop3:0xa8
    v_cmp_ge_u32 vcc, v24, v13
    v_bfi_b32 v19, v19, 0, v12
    v_bfi_b32 v20, v20, 0, v12
    s_and_b64 exec, exec, vcc
    s_cbranch_execz kms_placed
    ds_xor_b32 v21, v19 offset:40960
    ds_xor_b32 v22, v20 offset:41472
    s_cmp_lg_u32 s48, 0
    s_cbranch_scc1 kms_round
    ds_add_rtn_u32 v17, v5, v34 offset:41984
    v_lshrrev_b32 v13, 5, v5
    v_and_b32 v13, 4, v13
    s_waitcnt lgkmcnt(0)
    v_add_u32 v17, 44, v17
    v_cmp_gt_u32 vcc, 64, v17
    v_lshlrev_b32 v16, v17, v34
    v_add_u32 v24, 1, v17
    s_andn2_b64 s[38:39], exec, vcc
    s_and_b64 exec, exec, vcc
    ds_or_b32 v6, v16 offset:41728
    ds_max_u32 v13, v24 offset:42240
    s_mov_b64 exec, s[38:39]
    s_cbranch_execnz kms_ovf
kms_placed:
    s_mov_b64 exec, s[36:37]
    v_mul_u32_u24 v16, 36, v5
    v_lshl_add_u32 v16, v17, 1, v16
    ds_write_b16 v16, v4 offset:43008
    s_mov_b64 exec, -1
    s_add_u32 s40, s40, 1024
    s_cmp_lt_u32 s40, s47
    s_cbranch_scc1 kms_next
kms_rdone:
    s_mov_b32 s36, 0x3b203b20
    s_mov_b32 s37, 0x3b203b20
    s_cmp_lg_u32 s41, 0
    s_cbranch_scc1 kms_more
    v_mov_b32 v29, 42264
    s_mov_b64 exec, 1
    ds_add_u32 v29, v34
    s_mov_b64 exec, -1
    s_cmp_ge_u32 s14, 13
    s_cbranch_scc1 kms_late
kms_cw:
    ds_read_b32 v30, v29
    s_waitcnt lgkmcnt(0)
    v_readfirstlane_b32 s15, v30
    s_cmp_eq_u32 s15, 16
    s_cbranch_scc1 kms_cd
    s_sleep 1
    s_branch kms_cw
kms_cd:
    s_cmp_ge_u32 s14, 8
    s_cbranch_scc1 kms_join
    ds_read_b32 v12, v36 offset:41472
    ds_read_b128 v[4:7], v35 offset:43008
    ds_read_b128 v[8:11], v35 offset:43024
    s_waitcnt lgkmcnt(2)
    v_bfrev_b32 v12, v12
    v_lshlrev_b32 v12, v37, v12
    v_cmp_le_i32 s[20:21], 0, v12
    v_lshlrev_b32 v12, s44, v12
    v_cmp_le_i32 s[22:23], 0, v12
    v_lshlrev_b32 v12, s44, v12
    v_cmp_le_i32 s[24:25], 0, v12
    v_lshlrev_b32 v12, s44, v12
    v_cmp_le_i32 s[26:27], 0, v12
    v_lshlrev_b32 v12, s44, v12
    v_cmp_le_i32 s[28:29], 0, v12
    v_lshlrev_b32 v12, s44, v12
    v_cmp_le_i32 s[30:31], 0, v12
    v_lshlrev_b32 v12, s44, v12
    v_cmp_le_i32 s[32:33], 0, v12
    v_lshlrev_b32 v12, s44, v12
    v_cmp_le_i32 s[34:35], 0, v12
    s_cmp_eq_u32 s45, 0
    s_waitcnt lgkmcnt(0)
    s_cbranch_scc1 kms_nperm
    v_perm_b32 v4, v5, v4, v38
    v_perm_b32 v5, v7, v6, v38
    v_perm_b32 v6, v9, v8, v38
    v_perm_b32 v7, v11, v10, v38
kms_nperm:
    s_ff1_i32_b32 s20, s20
    s_ff1_i32_b32 s21, s21
    s_ff1_i32_b32 s22, s22
    s_ff1_i32_b32 s23, s23
    s_ff1_i32_b32 s24, s24
    s_ff1_i32_b32 s25, s25
    s_ff1_i32_b32 s26, s26
    s_ff1_i32_b32 s27, s27
    s_ff1_i32_b32 s28, s28
    s_ff1_i32_b32 s29, s29
    s_ff1_i32_b32 s30, s30
    s_ff1_i32_b32 s31, s31
    s_ff1_i32_b32 s32, s32
    s_ff1_i32_b32 s33, s33
    s_ff1_i32_b32 s34, s34
    s_ff1_i32_b32 s35, s35
    s_pack_ll_b32_b16 s20, s20, s22
    s_pack_ll_b32_b16 s21, s21, s23
    s_or_b64 s[20:21], s[20:21], s[36:37]
    s_pack_ll_b32_b16 s24, s24, s26
    s_pack_ll_b32_b16 s25, s25, s27
    s_or_b64 s[24:25], s[24:25], s[36:37]
    s_pack_ll_b32_b16 s28, s28, s30
    s_pack_ll_b32_b16 s29, s29, s31
    s_or_b64 s[28:29], s[28:29], s[36:37]
    s_pack_ll_b32_b16 s32, s32, s34
    s_pack_ll_b32_b16 s33, s33, s35
    s_or_b64 s[32:33], s[32:33], s[36:37]
    s_mov_b32 exec_hi, 0
    v_pk_min_u16 v4, v4, s20
    v_pk_min_u16 v5, v5, s24
    v_pk_min_u16 v6, v6, s28
    v_pk_min_u16 v7, v7, s32
    s_not_b64 exec, exec
    v_pk_min_u16 v4, v4, s21
    v_pk_min_u16 v5, v5, s25
    v_pk_min_u16 v6, v6, s29
    v_pk_min_u16 v7, v7, s33
    s_mov_b64 exec, -1
    global_store_dwordx4 v39, v[4:7], s[42:43] sc1
kms_join:
    s_cmp_lg_u32 s14, 12
    s_cbranch_scc1 km_nh
    s_cmp_ge_u32 s2, 160
    s_cbranch_scc1 km_nh
    v_mov_b32 v24, 42240
    ds_read_b128 v[26:29], v24
    s_lshl_b32 s78, s6, 7
    s_add_u32 s78, s78, 237568
    v_mov_b32 v24, s78
    s_mov_b64 exec, 1
    s_waitcnt lgkmcnt(0)
    v_mov_b32 v29, s90
    global_store_dwordx4 v24, v[26:29], s[4:5] sc1
    s_mov_b64 exec, -1
km_nh:
    s_mov_b32 s10, s14
    v_lshlrev_b32 v1, 4, v1
    s_lshr_b32 s8, s76, 3
    s_and_b32 s9, s76, 7
    s_mul_i32 s12, s8, 81920
    s_add_u32 s12, s12, 4194304
    s_add_u32 s20, s4, s12
    s_addc_u32 s21, s5, 0
    s_mov_b32 s19, 0x20000
    s_mov_b64 s[6:7], s[60:61]
    s_mov_b64 s[30:31], s[62:63]
    s_mov_b32 s29, s76
    s_mov_b32 s15, s77
    s_mov_b32 s42, s85
    s_mov_b32 s57, s86
    s_mul_i32 s46, s9, 20
    s_mov_b32 s28, 2
    s_mov_b32 s83, 32
    s_lshr_b32 s14, s10, 3
    s_mul_i32 s13, s14, 6
    s_bfe_u32 s12, s10, 0x10001
    s_add_u32 s50, s12, s13
    s_add_u32 s47, s46, s50
    s_cmp_ge_u32 s10, 4
    s_cselect_b32 s13, 4, 2
    s_add_u32 s51, s10, s13
    s_add_u32 s46, s46, s51
    s_cmp_eq_u32 s57, 0
    s_cselect_b32 s50, s46, s47
    s_lshl_b32 s50, s50, 7
    s_add_u32 s50, s50, 237568
    s_lshl_b32 s51, s46, 7
    s_add_u32 s51, s51, 237568
    s_lshl_b32 s12, s8, 7
    s_add_u32 s12, s12, 262112
    v_add_u32 v0, s12, v1
    v_writelane_b32 v0, s50, 0
    v_writelane_b32 v0, s51, 1
    s_lshl_b32 s12, s46, 13
    s_add_u32 s12, s12, 2101248
    s_add_u32 s22, s4, s12
    s_addc_u32 s23, s5, 0
    s_lshl_b32 s12, s47, 1
    s_and_b32 s13, s10, 1
    s_add_u32 s14, s12, s13
    s_lshl_b32 s12, s14, 12
    s_add_u32 s12, s12, 2097152
    s_add_u32 s44, s4, s12
    s_addc_u32 s45, s5, 0
    s_add_u32 s24, s20, 2621440
    s_addc_u32 s25, s21, 0
    s_add_u32 s58, s20, 5242880
    s_addc_u32 s59, s21, 0
    v_lshrrev_b32 v24, 1, v1
    s_lshl_b32 s12, s46, 9
    v_add_u32 v9, s12, v24
    s_lshl_b32 s12, s14, 8
    v_and_b32 v24, 0xf8, v24
    v_add_u32 v8, s12, v24
    v_lshrrev_b32 v24, 2, v8
    v_lshrrev_b32 v25, 2, v9
    buffer_load_ushort v6, v24, s[72:75], 0 offen
    buffer_load_ushort v7, v25, s[72:75], 0 offen
    v_mov_b32 v10, 0
    v_mov_b32 v11, 0
    v_mov_b32 v14, 0
    v_mov_b32 v15, 0
    s_cmp_lt_u32 s10, 14
    s_cbranch_scc1 km_j0
    s_waitcnt vmcnt(0)
km_j0:
    s_cmp_lt_u32 s2, 162
    s_cbranch_scc1 km_j1
    s_barrier
km_j1:
    v_mov_b32 v36, 122560
    v_mov_b32 v24, 1
    s_mov_b64 exec, 1
    ds_add_u32 v36, v24
    s_mov_b64 exec, 0x3ff
km_hp:
    global_load_dwordx4 v[26:29], v0, s[4:5] sc1
    s_waitcnt vmcnt(0)
    v_cmp_ne_u32 vcc, s90, v29
    s_cbranch_vccz km_hd
    s_sleep 2
    s_branch km_hp
km_hd:
    s_mov_b64 exec, -1
    v_mov_b32 v3, v127
    v_lshlrev_b32 v6, 16, v6
    v_lshlrev_b32 v7, 16, v7
    v_mov_b32 v90, 0
    v_mov_b32 v94, 0
    v_mov_b32 v112, 0
    v_mov_b32 v116, 0
    v_mov_b32 v120, 0
    v_mov_b32 v124, 0
km_relist:
    s_cmp_eq_u32 s57, 0
    s_cbranch_scc1 km_noh
    global_load_dwordx4 v[112:115], v1, s[44:45] offset:0 sc1
    global_load_dwordx4 v[116:119], v1, s[44:45] offset:1024 sc1
    global_load_dwordx4 v[120:123], v1, s[44:45] offset:2048 sc1
km_noh:
    global_load_dwordx4 v[66:69], v1, s[22:23] offset:-4096 sc1
    global_load_dwordx4 v[70:73], v1, s[22:23] offset:-3072 sc1
    global_load_dwordx4 v[74:77], v1, s[22:23] offset:-2048 sc1
    global_load_dwordx4 v[78:81], v1, s[22:23] offset:-1024 sc1
    global_load_dwordx4 v[82:85], v1, s[22:23] offset:0 sc1
    global_load_dwordx4 v[86:89], v1, s[22:23] offset:1024 sc1
    s_waitcnt lgkmcnt(0)
    v_readlane_b32 s36, v26, 0
    v_readlane_b32 s37, v27, 0
    v_readlane_b32 s38, v28, 0
    v_readlane_b32 s32, v26, 1
    v_readlane_b32 s33, v27, 1
    v_readlane_b32 s34, v28, 1
    s_max_u32 s41, s32, s33
    s_max_u32 s41, s41, 44
    s_min_u32 s41, s41, 64
    s_bitcmp1_b32 s10, 0
    s_cselect_b32 s40, s37, s36
    s_max_u32 s40, s40, 44
    s_min_u32 s40, s40, 64
    s_add_u32 s40, s40, 1
    s_lshr_b32 s40, s40, 1
    s_mul_i32 s12, s40, s57
    s_cmp_le_u32 s12, 24
    s_cbranch_scc1 km_noh3
    global_load_dwordx4 v[124:127], v1, s[44:45] offset:3072 sc1
km_noh3:
    s_cmp_le_u32 s41, 48
    s_cbranch_scc1 km_no7
    global_load_dwordx4 v[90:93], v1, s[22:23] offset:2048 sc1
    s_cmp_le_u32 s41, 56
    s_cbranch_scc1 km_no7
    global_load_dwordx4 v[94:97], v1, s[22:23] offset:3072 sc1
km_no7:
    v_and_b32 v24, 16, v1
    v_mov_b32 v25, 0x3f80
    v_lshlrev_b32 v24, v24, v25
    s_mov_b32 s52, 0xcccccccc
    s_mov_b32 s53, 0xcccccccc
    v_cndmask_b32 v4, v24, 0, s[52:53]
    v_cndmask_b32 v5, 0, v24, s[52:53]
    s_cmp_ge_u32 s9, 4
    s_cselect_b32 s43, 40960, 0
    s_lshl_b32 s12, s8, 7
    s_add_u32 s12, s12, 12582912
    s_add_u32 s22, s4, s12
    s_addc_u32 s23, s5, 0
    s_lshl_b32 s12, s9, 5
    s_add_u32 s12, s12, s8
    s_lshl_b32 s12, s12, 2
    s_add_u32 s56, s12, 266240
    s_and_b32 s12, s10, 3
    s_cmp_ge_u32 s10, 8
    s_cselect_b32 s12, s10, s12
    s_add_u32 s12, s12, s9
    s_add_u32 s12, s12, 1
    s_and_b32 s12, s12, 7
    s_xor_b32 s13, s12, 4
    s_mul_i32 s68, s12, 10240
    s_mul_i32 s70, s13, 10240
    s_cmp_eq_u32 s13, s9
    s_cselect_b32 s73, 1, 2
    s_cselect_b32 s70, s68, s70
    s_add_u32 s69, s68, 2048
    s_add_u32 s71, s70, 2048
    s_cmp_lt_u32 s10, 4
    s_cbranch_scc1 km_jobs
    s_add_u32 s68, s68, 4096
    s_add_u32 s69, s70, 4096
    s_mov_b32 s73, 1
    s_cmp_lt_u32 s10, 8
    s_cbranch_scc1 km_jobs
    s_add_u32 s68, s68, 2048
    s_add_u32 s69, s68, 2048
    s_cmp_eq_u32 s12, s9
    s_cselect_b32 s73, 0, 1
km_jobs:
    s_cmp_ge_u32 s68, 40960
    s_cselect_b32 s84, 40960, 0
    s_add_u32 s84, s84, s68
    s_cmp_ge_u32 s69, 40960
    s_cselect_b32 s85, 40960, 0
    s_add_u32 s85, s85, s69
    s_cmp_ge_u32 s70, 40960
    s_cselect_b32 s86, 40960, 0
    s_add_u32 s87, s86, s71
    s_add_u32 s86, s86, s70
    s_mov_b32 s74, 5242880
    s_or_b32 s88, s38, s42
    s_or_b32 s89, s34, s42
    s_mov_b32 s75, s42
    s_cmp_lt_u32 s10, 4
    s_cselect_b32 s72, 1, 0
    s_cmp_eq_u32 s73, 0
    s_cselect_b32 s72, 1, s72
    v_mov_b32 v34, -1
    v_mov_b32 v35, -1
    v_and_b32 v24, 0x38, v8
    v_sub_u32 v0, v8, v24
    v_lshlrev_b32 v0, 8, v0
    v_lshl_add_u32 v0, v24, 1, v0
    v_and_b32 v24, 0x38, v9
    v_sub_u32 v2, v9, v24
    v_lshlrev_b32 v2, 8, v2
    v_lshl_add_u32 v2, v24, 1, v2
    s_mov_b64 s[16:17], s[24:25]
    s_mov_b32 s18, 81920
    s_getpc_b64 s[52:53]
km_pc:
    s_mul_i32 s12, s40, 20
    s_sub_u32 s13, s40, 28
    s_max_i32 s13, s13, 0
    s_lshl_b32 s13, s13, 3
    s_add_u32 s12, s12, s13
    s_sub_u32 s13, km_1_drain0-km_pc+80, s12
    s_add_u32 s64, s52, s13
    s_addc_u32 s65, s53, 0
    s_sub_u32 s13, km_0_drain0-km_pc+80, s12
    s_add_u32 s60, s52, s13
    s_addc_u32 s61, s53, 0
    s_mul_i32 s12, s41, 20
    s_sub_u32 s13, s41, 56
    s_max_i32 s13, s13, 0
    s_lshl_b32 s13, s13, 3
    s_add_u32 s12, s12, s13
    s_sub_u32 s13, km_1_drain1-km_pc+80, s12
    s_add_u32 s66, s52, s13
    s_addc_u32 s67, s53, 0
    s_sub_u32 s13, km_0_drain1-km_pc+80, s12
    s_add_u32 s62, s52, s13
    s_addc_u32 s63, s53, 0
    v_mov_b32 v18, 0
    v_mov_b32 v19, 0
    v_mov_b32 v20, 0
    v_mov_b32 v21, 0
    s_mov_b32 s11, 1
    s_waitcnt vmcnt(0)
    v_max_u32 v24, v66, v70
    v_max3_u32 v24, v24, v74, v78
    v_max3_u32 v24, v24, v82, v86
    v_max3_u32 v24, v24, v90, v94
    v_max3_u32 v24, v24, v112, v116
    v_max3_u32 v24, v24, v120, v124
    v_cmp_eq_u32 vcc, -1, v24
    s_cbranch_vccnz km_again
    v_mov_b32 v24, 1
    s_mov_b64 exec, 1
    ds_add_rtn_u32 v24, v36, v24 offset:4
    s_mov_b64 exec, -1
    s_mul_i32 s12, s9, 10240
    s_waitcnt lgkmcnt(0)
    v_readfirstlane_b32 s13, v24
    s_cmp_lg_u32 s13, 15
    s_cbranch_scc1 km_tc3
    v_lshl_add_u32 v24, v1, 3, s12
    global_load_dword v37, v24, s[24:25] sc1
    v_add_u32 v25, 8192, v24
    s_mov_b64 exec, 0xffff
    global_load_dword v37, v25, s[24:25] sc1
    global_load_dword v37, v25, s[58:59] sc1
    s_mov_b64 exec, -1
    global_load_dword v37, v24, s[58:59] sc1
km_tc3:
    v_lshlrev_b32_sdwa v38, 3, v66 dst_sel:DWORD dst_unused:UNUSED_PAD src0_sel:DWORD src1_sel:WORD_0
    v_lshlrev_b32_sdwa v39, 3, v66 dst_sel:DWORD dst_unused:UNUSED_PAD src0_sel:DWORD src1_sel:WORD_1
    v_lshlrev_b32_sdwa v40, 3, v67 dst_sel:DWORD dst_unused:UNUSED_PAD src0_sel:DWORD src1_sel:WORD_0
    v_lshlrev_b32_sdwa v41, 3, v67 dst_sel:DWORD dst_unused:UNUSED_PAD src0_sel:DWORD src1_sel:WORD_1
    v_lshlrev_b32_sdwa v42, 3, v68 dst_sel:DWORD dst_unused:UNUSED_PAD src0_sel:DWORD src1_sel:WORD_0
    v_lshlrev_b32_sdwa v43, 3, v68 dst_sel:DWORD dst_unused:UNUSED_PAD src0_sel:DWORD src1_sel:WORD_1
    v_lshlrev_b32_sdwa v44, 3, v69 dst_sel:DWORD dst_unused:UNUSED_PAD src0_sel:DWORD src1_sel:WORD_0
    v_lshlrev_b32_sdwa v45, 3, v69 dst_sel:DWORD dst_unused:UNUSED_PAD src0_sel:DWORD src1_sel:WORD_1
    v_lshlrev_b32_sdwa v46, 3, v70 dst_sel:DWORD dst_unused:UNUSED_PAD src0_sel:DWORD src1_sel:WORD_0
    v_lshlrev_b32_sdwa v47, 3, v70 dst_sel:DWORD dst_unused:UNUSED_PAD src0_sel:DWORD src1_sel:WORD_1
    v_lshlrev_b32_sdwa v48, 3, v71 dst_sel:DWORD dst_unused:UNUSED_PAD src0_sel:DWORD src1_sel:WORD_0
    v_lshlrev_b32_sdwa v49, 3, v71 dst_sel:DWORD dst_unused:UNUSED_PAD src0_sel:DWORD src1_sel:WORD_1
    v_lshlrev_b32_sdwa v50, 3, v72 dst_sel:DWORD dst_unused:UNUSED_PAD src0_sel:DWORD src1_sel:WORD_0
    v_lshlrev_b32_sdwa v51, 3, v72 dst_sel:DWORD dst_unused:UNUSED_PAD src0_sel:DWORD src1_sel:WORD_1
    v_lshlrev_b32_sdwa v52, 3, v73 dst_sel:DWORD dst_unused:UNUSED_PAD src0_sel:DWORD src1_sel:WORD_0
    v_lshlrev_b32_sdwa v53, 3, v73 dst_sel:DWORD dst_unused:UNUSED_PAD src0_sel:DWORD src1_sel:WORD_1
    v_lshlrev_b32_sdwa v54, 3, v74 dst_sel:DWORD dst_unused:UNUSED_PAD src0_sel:DWORD src1_sel:WORD_0
    v_lshlrev_b32_sdwa v55, 3, v74 dst_sel:DWORD dst_unused:UNUSED_PAD src0_sel:DWORD src1_sel:WORD_1
    v_lshlrev_b32_sdwa v56, 3, v75 dst_sel:DWORD dst_unused:UNUSED_PAD src0_sel:DWORD src1_sel:WORD_0
    v_lshlrev_b32_sdwa v57, 3, v75 dst_sel:DWORD dst_unused:UNUSED_PAD src0_sel:DWORD src1_sel:WORD_1
    v_lshlrev_b32_sdwa v58, 3, v76 dst_sel:DWORD dst_unused:UNUSED_PAD src0_sel:DWORD src1_sel:WORD_0
    v_lshlrev_b32_sdwa v59, 3, v76 dst_sel:DWORD dst_unused:UNUSED_PAD src0_sel:DWORD src1_sel:WORD_1
    v_lshlrev_b32_sdwa v60, 3, v77 dst_sel:DWORD dst_unused:UNUSED_PAD src0_sel:DWORD src1_sel:WORD_0
    v_lshlrev_b32_sdwa v61, 3, v77 dst_sel:DWORD dst_unused:UNUSED_PAD src0_sel:DWORD src1_sel:WORD_1
    v_lshlrev_b32_sdwa v62, 3, v78 dst_sel:DWORD dst_unused:UNUSED_PAD src0_sel:DWORD src1_sel:WORD_0
    v_lshlrev_b32_sdwa v63, 3, v78 dst_sel:DWORD dst_unused:UNUSED_PAD src0_sel:DWORD src1_sel:WORD_1
    v_lshlrev_b32_sdwa v64, 3, v79 dst_sel:DWORD dst_unused:UNUSED_PAD src0_sel:DWORD src1_sel:WORD_0
    v_lshlrev_b32_sdwa v65, 3, v79 dst_sel:DWORD dst_unused:UNUSED_PAD src0_sel:DWORD src1_sel:WORD_1
    v_lshlrev_b32_sdwa v66, 3, v80 dst_sel:DWORD dst_unused:UNUSED_PAD src0_sel:DWORD src1_sel:WORD_0
    v_lshlrev_b32_sdwa v67, 3, v80 dst_sel:DWORD dst_unused:UNUSED_PAD src0_sel:DWORD src1_sel:WORD_1
    v_lshlrev_b32_sdwa v68, 3, v81 dst_sel:DWORD dst_unused:UNUSED_PAD src0_sel:DWORD src1_sel:WORD_0
    v_lshlrev_b32_sdwa v69, 3, v81 dst_sel:DWORD dst_unused:UNUSED_PAD src0_sel:DWORD src1_sel:WORD_1
    v_lshlrev_b32_sdwa v70, 3, v82 dst_sel:DWORD dst_unused:UNUSED_PAD src0_sel:DWORD src1_sel:WORD_0
    v_lshlrev_b32_sdwa v71, 3, v82 dst_sel:DWORD dst_unused:UNUSED_PAD src0_sel:DWORD src1_sel:WORD_1
    v_lshlrev_b32_sdwa v72, 3, v83 dst_sel:DWORD dst_unused:UNUSED_PAD src0_sel:DWORD src1_sel:WORD_0
    v_lshlrev_b32_sdwa v73, 3, v83 dst_sel:DWORD dst_unused:UNUSED_PAD src0_sel:DWORD src1_sel:WORD_1
    v_lshlrev_b32_sdwa v74, 3, v84 dst_sel:DWORD dst_unused:UNUSED_PAD src0_sel:DWORD src1_sel:WORD_0
    v_lshlrev_b32_sdwa v75, 3, v84 dst_sel:DWORD dst_unused:UNUSED_PAD src0_sel:DWORD src1_sel:WORD_1
    v_lshlrev_b32_sdwa v76, 3, v85 dst_sel:DWORD dst_unused:UNUSED_PAD src0_sel:DWORD src1_sel:WORD_0
    v_lshlrev_b32_sdwa v77, 3, v85 dst_sel:DWORD dst_unused:UNUSED_PAD src0_sel:DWORD src1_sel:WORD_1
    v_lshlrev_b32_sdwa v78, 3, v86 dst_sel:DWORD dst_unused:UNUSED_PAD src0_sel:DWORD src1_sel:WORD_0
    v_lshlrev_b32_sdwa v79, 3, v86 dst_sel:DWORD dst_unused:UNUSED_PAD src0_sel:DWORD src1_sel:WORD_1
    v_lshlrev_b32_sdwa v80, 3, v87 dst_sel:DWORD dst_unused:UNUSED_PAD src0_sel:DWORD src1_sel:WORD_0
    v_lshlrev_b32_sdwa v81, 3, v87 dst_sel:DWORD dst_unused:UNUSED_PAD src0_sel:DWORD src1_sel:WORD_1
    v_lshlrev_b32_sdwa v82, 3, v88 dst_sel:DWORD dst_unused:UNUSED_PAD src0_sel:DWORD src1_sel:WORD_0
    v_lshlrev_b32_sdwa v83, 3, v88 dst_sel:DWORD dst_unused:UNUSED_PAD src0_sel:DWORD src1_sel:WORD_1
    v_lshlrev_b32_sdwa v84, 3, v89 dst_sel:DWORD dst_unused:UNUSED_PAD src0_sel:DWORD src1_sel:WORD_0
    v_lshlrev_b32_sdwa v85, 3, v89 dst_sel:DWORD dst_unused:UNUSED_PAD src0_sel:DWORD src1_sel:WORD_1
    v_lshlrev_b32_sdwa v86, 3, v90 dst_sel:DWORD dst_unused:UNUSED_PAD src0_sel:DWORD src1_sel:WORD_0
    v_lshlrev_b32_sdwa v87, 3, v90 dst_sel:DWORD dst_unused:UNUSED_PAD src0_sel:DWORD src1_sel:WORD_1
    v_lshlrev_b32_sdwa v88, 3, v91 dst_sel:DWORD dst_unused:UNUSED_PAD src0_sel:DWORD src1_sel:WORD_0
    v_lshlrev_b32_sdwa v89, 3, v91 dst_sel:DWORD dst_unused:UNUSED_PAD src0_sel:DWORD src1_sel:WORD_1
    v_lshlrev_b32_sdwa v90, 3, v92 dst_sel:DWORD dst_unused:UNUSED_PAD src0_sel:DWORD src1_sel:WORD_0
    v_lshlrev_b32_sdwa v91, 3, v92 dst_sel:DWORD dst_unused:UNUSED_PAD src0_sel:DWORD src1_sel:WORD_1
    v_lshlrev_b32_sdwa v92, 3, v93 dst_sel:DWORD dst_unused:UNUSED_PAD src0_sel:DWORD src1_sel:WORD_0
    v_lshlrev_b32_sdwa v93, 3, v93 dst_sel:DWORD dst_unused:UNUSED_PAD src0_sel:DWORD src1_sel:WORD_1
    s_cmp_eq_u32 s57, 0
    s_cbranch_scc1 km_twfull
    v_lshlrev_b32_sdwa v98, 3, v112 dst_sel:DWORD dst_unused:UNUSED_PAD src0_sel:DWORD src1_sel:WORD_0
    v_lshlrev_b32_sdwa v99, 3, v112 dst_sel:DWORD dst_unused:UNUSED_PAD src0_sel:DWORD src1_sel:WORD_1
    v_lshlrev_b32_sdwa v100, 3, v113 dst_sel:DWORD dst_unused:UNUSED_PAD src0_sel:DWORD src1_sel:WORD_0
    v_lshlrev_b32_sdwa v101, 3, v113 dst_sel:DWORD dst_unused:UNUSED_PAD src0_sel:DWORD src1_sel:WORD_1
    v_lshlrev_b32_sdwa v102, 3, v114 dst_sel:DWORD dst_unused:UNUSED_PAD src0_sel:DWORD src1_sel:WORD_0
    v_lshlrev_b32_sdwa v103, 3, v114 dst_sel:DWORD dst_unused:UNUSED_PAD src0_sel:DWORD src1_sel:WORD_1
    v_lshlrev_b32_sdwa v104, 3, v115 dst_sel:DWORD dst_unused:UNUSED_PAD src0_sel:DWORD src1_sel:WORD_0
    v_lshlrev_b32_sdwa v105, 3, v115 dst_sel:DWORD dst_unused:UNUSED_PAD src0_sel:DWORD src1_sel:WORD_1
    v_lshlrev_b32_sdwa v106, 3, v116 dst_sel:DWORD dst_unused:UNUSED_PAD src0_sel:DWORD src1_sel:WORD_0
    v_lshlrev_b32_sdwa v107, 3, v116 dst_sel:DWORD dst_unused:UNUSED_PAD src0_sel:DWORD src1_sel:WORD_1
    v_lshlrev_b32_sdwa v108, 3, v117 dst_sel:DWORD dst_unused:UNUSED_PAD src0_sel:DWORD src1_sel:WORD_0
    v_lshlrev_b32_sdwa v109, 3, v117 dst_sel:DWORD dst_unused:UNUSED_PAD src0_sel:DWORD src1_sel:WORD_1
    v_lshlrev_b32_sdwa v110, 3, v118 dst_sel:DWORD dst_unused:UNUSED_PAD src0_sel:DWORD src1_sel:WORD_0
    v_lshlrev_b32_sdwa v111, 3, v118 dst_sel:DWORD dst_unused:UNUSED_PAD src0_sel:DWORD src1_sel:WORD_1
    v_lshlrev_b32_sdwa v112, 3, v119 dst_sel:DWORD dst_unused:UNUSED_PAD src0_sel:DWORD src1_sel:WORD_0
    v_lshlrev_b32_sdwa v113, 3, v119 dst_sel:DWORD dst_unused:UNUSED_PAD src0_sel:DWORD src1_sel:WORD_1
    v_lshlrev_b32_sdwa v114, 3, v120 dst_sel:DWORD dst_unused:UNUSED_PAD src0_sel:DWORD src1_sel:WORD_0
    v_lshlrev_b32_sdwa v115, 3, v120 dst_sel:DWORD dst_unused:UNUSED_PAD src0_sel:DWORD src1_sel:WORD_1
    v_lshlrev_b32_sdwa v116, 3, v121 dst_sel:DWORD dst_unused:UNUSED_PAD src0_sel:DWORD src1_sel:WORD_0
    v_lshlrev_b32_sdwa v117, 3, v121 dst_sel:DWORD dst_unused:UNUSED_PAD src0_sel:DWORD src1_sel:WORD_1
    v_lshlrev_b32_sdwa v118, 3, v122 dst_sel:DWORD dst_unused:UNUSED_PAD src0_sel:DWORD src1_sel:WORD_0
    v_lshlrev_b32_sdwa v119, 3, v122 dst_sel:DWORD dst_unused:UNUSED_PAD src0_sel:DWORD src1_sel:WORD_1
    v_lshlrev_b32_sdwa v120, 3, v123 dst_sel:DWORD dst_unused:UNUSED_PAD src0_sel:DWORD src1_sel:WORD_0
    v_lshlrev_b32_sdwa v121, 3, v123 dst_sel:DWORD dst_unused:UNUSED_PAD src0_sel:DWORD src1_sel:WORD_1
    v_lshlrev_b32_sdwa v122, 3, v124 dst_sel:DWORD dst_unused:UNUSED_PAD src0_sel:DWORD src1_sel:WORD_0
    v_lshlrev_b32_sdwa v123, 3, v124 dst_sel:DWORD dst_unused:UNUSED_PAD src0_sel:DWORD src1_sel:WORD_1
    v_lshlrev_b32_sdwa v124, 3, v125 dst_sel:DWORD dst_unused:UNUSED_PAD src0_sel:DWORD src1_sel:WORD_0
    v_lshlrev_b32_sdwa v125, 3, v125 dst_sel:DWORD dst_unused:UNUSED_PAD src0_sel:DWORD src1_sel:WORD_1
km_twhalf:
    ds_read_b32 v24, v36
    s_waitcnt lgkmcnt(0)
    v_readfirstlane_b32 s12, v24
    s_cmp_eq_u32 s12, 16
    s_cbranch_scc1 km_1_half
    s_sleep 1
    s_branch km_twhalf
km_twfull:
    ds_read_b32 v24, v36
    s_waitcnt lgkmcnt(0)
    v_readfirstlane_b32 s12, v24
    s_cmp_eq_u32 s12, 16
    s_cbranch_scc1 km_1_full
    s_sleep 1
    s_branch km_twfull
km_1_hop:
    s_cmp_eq_u32 s57, 0
    s_barrier
    s_cbranch_scc1 km_1_light
    ds_read_b64 v[26:27], v98 offset:0
    ds_read_b64 v[28:29], v99 offset:0
    ds_read_b64 v[30:31], v100 offset:0
    ds_read_b64 v[32:33], v101 offset:0
    s_mov_b64 s[16:17], s[58:59]
    s_mov_b64 s[58:59], s[54:55]
    s_cmp_lg_u32 s75, 0
    s_cbranch_scc1 km_1_rs0
    global_store_dwordx2 v8, v[34:35], s[58:59]
    global_store_dwordx2 v9, v[34:35], s[58:59]
km_1_nors0:
km_1_go0:
    s_cmp_eq_u32 s40, 32
    s_cbranch_scc1 km_1_tw0
    s_waitcnt lgkmcnt(0)
    s_setpc_b64 s[64:65]
km_1_tw0:
    s_waitcnt lgkmcnt(0)
km_1_top0:
    v_lshlrev_b32_sdwa v25, 3, v127 dst_sel:DWORD dst_unused:UNUSED_PAD src0_sel:DWORD src1_sel:WORD_1
    s_waitcnt lgkmcnt(3)
    v_mfma_f32_4x4x4_16b_bf16 v[18:21], v[4:5], v[28:29], v[18:21]
    ds_read_b64 v[28:29], v25 offset:0
    v_lshlrev_b32_sdwa v24, 3, v127 dst_sel:DWORD dst_unused:UNUSED_PAD src0_sel:DWORD src1_sel:WORD_0
    s_waitcnt lgkmcnt(3)
    v_mfma_f32_4x4x4_16b_bf16 v[18:21], v[4:5], v[30:31], v[18:21]
    ds_read_b64 v[30:31], v24 offset:0
    v_lshlrev_b32_sdwa v25, 3, v126 dst_sel:DWORD dst_unused:UNUSED_PAD src0_sel:DWORD src1_sel:WORD_1
    s_waitcnt lgkmcnt(3)
    v_mfma_f32_4x4x4_16b_bf16 v[18:21], v[4:5], v[32:33], v[18:21]
    ds_read_b64 v[32:33], v25 offset:0
    v_lshlrev_b32_sdwa v24, 3, v126 dst_sel:DWORD dst_unused:UNUSED_PAD src0_sel:DWORD src1_sel:WORD_0
    s_waitcnt lgkmcnt(3)
    v_mfma_f32_4x4x4_16b_bf16 v[18:21], v[4:5], v[26:27], v[18:21]
    ds_read_b64 v[26:27], v24 offset:0
    s_waitcnt lgkmcnt(3)
    v_mfma_f32_4x4x4_16b_bf16 v[18:21], v[4:5], v[28:29], v[18:21]
    ds_read_b64 v[28:29], v125 offset:0
    s_waitcnt lgkmcnt(3)
    v_mfma_f32_4x4x4_16b_bf16 v[18:21], v[4:5], v[30:31], v[18:21]
    ds_read_b64 v[30:31], v124 offset:0
    s_waitcnt lgkmcnt(3)
    v_mfma_f32_4x4x4_16b_bf16 v[18:21], v[4:5], v[32:33], v[18:21]
    ds_read_b64 v[32:33], v123 offset:0
    s_waitcnt lgkmcnt(3)
    v_mfma_f32_4x4x4_16b_bf16 v[18:21], v[4:5], v[26:27], v[18:21]
    ds_read_b64 v[26:27], v122 offset:0
    s_waitcnt lgkmcnt(3)
    v_mfma_f32_4x4x4_16b_bf16 v[18:21], v[4:5], v[28:29], v[18:21]
    ds_read_b64 v[28:29], v121 offset:0
    s_waitcnt lgkmcnt(3)
    v_mfma_f32_4x4x4_16b_bf16 v[18:21], v[4:5], v[30:31], v[18:21]
    ds_read_b64 v[30:31], v120 offset:0
    s_waitcnt lgkmcnt(3)
    v_mfma_f32_4x4x4_16b_bf16 v[18:21], v[4:5], v[32:33], v[18:21]
    ds_read_b64 v[32:33], v119 offset:0
    s_waitcnt lgkmcnt(3)
    v_mfma_f32_4x4x4_16b_bf16 v[18:21], v[4:5], v[26:27], v[18:21]
    ds_read_b64 v[26:27], v118 offset:0
    s_waitcnt lgkmcnt(3)
    v_mfma_f32_4x4x4_16b_bf16 v[18:21], v[4:5], v[28:29], v[18:21]
    ds_read_b64 v[28:29], v117 offset:0
    s_waitcnt lgkmcnt(3)
    v_mfma_f32_4x4x4_16b_bf16 v[18:21], v[4:5], v[30:31], v[18:21]
    ds_read_b64 v[30:31], v116 offset:0
    s_waitcnt lgkmcnt(3)
    v_mfma_f32_4x4x4_16b_bf16 v[18:21], v[4:5], v[32:33], v[18:21]
    ds_read_b64 v[32:33], v115 offset:0
    s_waitcnt lgkmcnt(3)
    v_mfma_f32_4x4x4_16b_bf16 v[18:21], v[4:5], v[26:27], v[18:21]
    ds_read_b64 v[26:27], v114 offset:0
    s_waitcnt lgkmcnt(3)
    v_mfma_f32_4x4x4_16b_bf16 v[18:21], v[4:5], v[28:29], v[18:21]
    ds_read_b64 v[28:29], v113 offset:0
    s_waitcnt lgkmcnt(3)
    v_mfma_f32_4x4x4_16b_bf16 v[18:21], v[4:5], v[30:31], v[18:21]
    ds_read_b64 v[30:31], v112 offset:0
    s_waitcnt lgkmcnt(3)
    v_mfma_f32_4x4x4_16b_bf16 v[18:21], v[4:5], v[32:33], v[18:21]
    ds_read_b64 v[32:33], v111 offset:0
    s_waitcnt lgkmcnt(3)
    v_mfma_f32_4x4x4_16b_bf16 v[18:21], v[4:5], v[26:27], v[18:21]
    ds_read_b64 v[26:27], v110 offset:0
    s_waitcnt lgkmcnt(3)
    v_mfma_f32_4x4x4_16b_bf16 v[18:21], v[4:5], v[28:29], v[18:21]
    ds_read_b64 v[28:29], v109 offset:0
    s_waitcnt lgkmcnt(3)
    v_mfma_f32_4x4x4_16b_bf16 v[18:21], v[4:5], v[30:31], v[18:21]
    ds_read_b64 v[30:31], v108 offset:0
    s_waitcnt lgkmcnt(3)
    v_mfma_f32_4x4x4_16b_bf16 v[18:21], v[4:5], v[32:33], v[18:21]
    ds_read_b64 v[32:33], v107 offset:0
    s_waitcnt lgkmcnt(3)
    v_mfma_f32_4x4x4_16b_bf16 v[18:21], v[4:5], v[26:27], v[18:21]
    ds_read_b64 v[26:27], v106 offset:0
    s_waitcnt lgkmcnt(3)
    v_mfma_f32_4x4x4_16b_bf16 v[18:21], v[4:5], v[28:29], v[18:21]
    ds_read_b64 v[28:29], v105 offset:0
    s_waitcnt lgkmcnt(3)
    v_mfma_f32_4x4x4_16b_bf16 v[18:21], v[4:5], v[30:31], v[18:21]
    ds_read_b64 v[30:31], v104 offset:0
    s_waitcnt lgkmcnt(3)
    v_mfma_f32_4x4x4_16b_bf16 v[18:21], v[4:5], v[32:33], v[18:21]
    ds_read_b64 v[32:33], v103 offset:0
    s_waitcnt lgkmcnt(3)
    v_mfma_f32_4x4x4_16b_bf16 v[18:21], v[4:5], v[26:27], v[18:21]
    ds_read_b64 v[26:27], v102 offset:0
km_1_drain0:
    s_waitcnt lgkmcnt(3)
    v_mfma_f32_4x4x4_16b_bf16 v[18:21], v[4:5], v[28:29], v[18:21]
    s_waitcnt lgkmcnt(2)
    s_cmp_lg_u32 s88, 0
    v_mfma_f32_4x4x4_16b_bf16 v[18:21], v[4:5], v[30:31], v[18:21]
    s_waitcnt lgkmcnt(1)
    s_nop 0
    v_mfma_f32_4x4x4_16b_bf16 v[18:21], v[4:5], v[32:33], v[18:21]
    s_waitcnt lgkmcnt(0)
    s_nop 0
    v_mfma_f32_4x4x4_16b_bf16 v[18:21], v[4:5], v[26:27], v[18:21]
    s_cbranch_scc1 km_1_sp0
    v_add_u32 v24, s43, v8
    s_nop 2
    v_mov_b32 v26, v18
    v_mov_b32 v27, v19
    v_mov_b32 v28, v20
    v_mov_b32 v29, v21
    v_permlane32_swap_b32 v18, v26
    v_permlane32_swap_b32 v19, v27
    v_permlane32_swap_b32 v20, v28
    v_permlane32_swap_b32 v21, v29
    v_add_f32 v18, v18, v26
    v_add_f32 v19, v19, v27
    v_add_f32 v20, v20, v28
    v_add_f32 v21, v21, v29
    v_mul_f32 v18, v6, v18
    v_mul_f32 v19, v6, v19
    v_mul_f32 v20, v6, v20
    v_mul_f32 v21, v6, v21
    v_mul_f32 v26, v6, v18
    v_mul_f32 v27, v6, v19
    v_mul_f32 v28, v6, v20
    v_mul_f32 v29, v6, v21
    v_cvt_pk_bf16_f32 v22, v26, v27
    v_cvt_pk_bf16_f32 v23, v28, v29
    v_min_u32 v22, -2, v22
    global_store_dwordx2 v8, v[22:23], s[16:17]
km_1_pub0:
    ds_write_b64 v24, v[22:23] offset:40960
    v_cvt_pk_bf16_f32 v12, v18, v19
    v_cvt_pk_bf16_f32 v13, v20, v21
    v_mov_b64 v[18:19], 0
    v_mov_b64 v[20:21], 0
km_1_full:
    ds_read_b64 v[26:27], v38 offset:0
    ds_read_b64 v[28:29], v39 offset:0
    ds_read_b64 v[30:31], v40 offset:0
    ds_read_b64 v[32:33], v41 offset:0
km_1_go1:
    s_cmp_eq_u32 s41, 64
    s_cbranch_scc1 km_1_tw1
    s_waitcnt lgkmcnt(0)
    s_setpc_b64 s[66:67]
km_1_light:
    ds_read_b64 v[26:27], v38 offset:0
    ds_read_b64 v[28:29], v39 offset:0
    ds_read_b64 v[30:31], v40 offset:0
    ds_read_b64 v[32:33], v41 offset:0
    s_mov_b64 s[16:17], s[58:59]
    s_mov_b64 s[58:59], s[54:55]
    s_cmp_lg_u32 s75, 0
    s_cbranch_scc1 km_1_rs1
    global_store_dwordx2 v9, v[34:35], s[58:59]
km_1_nors1:
    s_cmp_lg_u32 s10, 15
    s_cbranch_scc1 km_1_go1
    s_cmp_lg_u32 s11, 7
    s_cbranch_scc1 km_1_an2
    v_mov_b32 v24, s56
    v_mov_b32 v25, s90
    s_mov_b64 exec, 1
    global_store_dword v24, v25, s[4:5] sc1
    s_mov_b64 exec, -1
km_1_an2:
    s_lshl_b32 s12, s9, 5
    s_add_u32 s12, s12, s8
    s_mul_i32 s12, s12, 81920
    s_lshl_b32 s13, s11, 11
    s_add_u32 s12, s12, s13
    s_add_u32 s12, s12, 12576768
    v_and_b32 v24, 0x1f0, v1
    v_and_b32 v25, 0x200, v1
    v_lshlrev_b32 v25, 5, v25
    v_lshl_add_u32 v24, v24, 3, v25
    v_add_u32 v24, s12, v24
    global_load_dword v37, v24, s[4:5] sc1
    v_add_u32 v24, 32768, v24
    global_load_dword v37, v24, s[4:5] sc1
    v_add_u32 v24, 32768, v24
    s_mov_b32 exec_hi, 0
    global_load_dword v37, v24, s[4:5] sc1
    s_mov_b32 exec_hi, -1
    s_branch km_1_go1
km_1_tw1:
    s_waitcnt lgkmcnt(0)
km_1_top1:
    v_lshlrev_b32_sdwa v25, 3, v97 dst_sel:DWORD dst_unused:UNUSED_PAD src0_sel:DWORD src1_sel:WORD_1
    s_waitcnt lgkmcnt(3)
    v_mfma_f32_4x4x4_16b_bf16 v[18:21], v[4:5], v[28:29], v[18:21]
    ds_read_b64 v[28:29], v25 offset:0
    v_lshlrev_b32_sdwa v24, 3, v97 dst_sel:DWORD dst_unused:UNUSED_PAD src0_sel:DWORD src1_sel:WORD_0
    s_waitcnt lgkmcnt(3)
    v_mfma_f32_4x4x4_16b_bf16 v[18:21], v[4:5], v[30:31], v[18:21]
    ds_read_b64 v[30:31], v24 offset:0
    v_lshlrev_b32_sdwa v25, 3, v96 dst_sel:DWORD dst_unused:UNUSED_PAD src0_sel:DWORD src1_sel:WORD_1
    s_waitcnt lgkmcnt(3)
    v_mfma_f32_4x4x4_16b_bf16 v[18:21], v[4:5], v[32:33], v[18:21]
    ds_read_b64 v[32:33], v25 offset:0
    v_lshlrev_b32_sdwa v24, 3, v96 dst_sel:DWORD dst_unused:UNUSED_PAD src0_sel:DWORD src1_sel:WORD_0
    s_waitcnt lgkmcnt(3)
    v_mfma_f32_4x4x4_16b_bf16 v[18:21], v[4:5], v[26:27], v[18:21]
    ds_read_b64 v[26:27], v24 offset:0
    v_lshlrev_b32_sdwa v25, 3, v95 dst_sel:DWORD dst_unused:UNUSED_PAD src0_sel:DWORD src1_sel:WORD_1
    s_waitcnt lgkmcnt(3)
    v_mfma_f32_4x4x4_16b_bf16 v[18:21], v[4:5], v[28:29], v[18:21]
    ds_read_b64 v[28:29], v25 offset:0
    v_lshlrev_b32_sdwa v24, 3, v95 dst_sel:DWORD dst_unused:UNUSED_PAD src0_sel:DWORD src1_sel:WORD_0
    s_waitcnt lgkmcnt(3)
    v_mfma_f32_4x4x4_16b_bf16 v[18:21], v[4:5], v[30:31], v[18:21]
    ds_read_b64 v[30:31], v24 offset:0
    v_lshlrev_b32_sdwa v25, 3, v94 dst_sel:DWORD dst_unused:UNUSED_PAD src0_sel:DWORD src1_sel:WORD_1
    s_waitcnt lgkmcnt(3)
    v_mfma_f32_4x4x4_16b_bf16 v[18:21], v[4:5], v[32:33], v[18:21]
    ds_read_b64 v[32:33], v25 offset:0
    v_lshlrev_b32_sdwa v24, 3, v94 dst_sel:DWORD dst_unused:UNUSED_PAD src0_sel:DWORD src1_sel:WORD_0
    s_waitcnt lgkmcnt(3)
    v_mfma_f32_4x4x4_16b_bf16 v[18:21], v[4:5], v[26:27], v[18:21]
    ds_read_b64 v[26:27], v24 offset:0
    s_waitcnt lgkmcnt(3)
    v_mfma_f32_4x4x4_16b_bf16 v[18:21], v[4:5], v[28:29], v[18:21]
    ds_read_b64 v[28:29], v93 offset:0
    s_waitcnt lgkmcnt(3)
    v_mfma_f32_4x4x4_16b_bf16 v[18:21], v[4:5], v[30:31], v[18:21]
    ds_read_b64 v[30:31], v92 offset:0
    s_waitcnt lgkmcnt(3)
    v_mfma_f32_4x4x4_16b_bf16 v[18:21], v[4:5], v[32:33], v[18:21]
    ds_read_b64 v[32:33], v91 offset:0
    s_waitcnt lgkmcnt(3)
    v_mfma_f32_4x4x4_16b_bf16 v[18:21], v[4:5], v[26:27], v[18:21]
    ds_read_b64 v[26:27], v90 offset:0
    s_waitcnt lgkmcnt(3)
    v_mfma_f32_4x4x4_16b_bf16 v[18:21], v[4:5], v[28:29], v[18:21]
    ds_read_b64 v[28:29], v89 offset:0
    s_waitcnt lgkmcnt(3)
    v_mfma_f32_4x4x4_16b_bf16 v[18:21], v[4:5], v[30:31], v[18:21]
    ds_read_b64 v[30:31], v88 offset:0
    s_waitcnt lgkmcnt(3)
    v_mfma_f32_4x4x4_16b_bf16 v[18:21], v[4:5], v[32:33], v[18:21]
    ds_read_b64 v[32:33], v87 offset:0
    s_waitcnt lgkmcnt(3)
    v_mfma_f32_4x4x4_16b_bf16 v[18:21], v[4:5], v[26:27], v[18:21]
    ds_read_b64 v[26:27], v86 offset:0
    s_waitcnt lgkmcnt(3)
    v_mfma_f32_4x4x4_16b_bf16 v[18:21], v[4:5], v[28:29], v[18:21]
    ds_read_b64 v[28:29], v85 offset:0
    s_waitcnt lgkmcnt(3)
    v_mfma_f32_4x4x4_16b_bf16 v[18:21], v[4:5], v[30:31], v[18:21]
    ds_read_b64 v[30:31], v84 offset:0
    s_waitcnt lgkmcnt(3)
    v_mfma_f32_4x4x4_16b_bf16 v[18:21], v[4:5], v[32:33], v[18:21]
    ds_read_b64 v[32:33], v83 offset:0
    s_waitcnt lgkmcnt(3)
    v_mfma_f32_4x4x4_16b_bf16 v[18:21], v[4:5], v[26:27], v[18:21]
    ds_read_b64 v[26:27], v82 offset:0
    s_waitcnt lgkmcnt(3)
    v_mfma_f32_4x4x4_16b_bf16 v[18:21], v[4:5], v[28:29], v[18:21]
    ds_read_b64 v[28:29], v81 offset:0
    s_waitcnt lgkmcnt(3)
    v_mfma_f32_4x4x4_16b_bf16 v[18:21], v[4:5], v[30:31], v[18:21]
    ds_read_b64 v[30:31], v80 offset:0
    s_waitcnt lgkmcnt(3)
    v_mfma_f32_4x4x4_16b_bf16 v[18:21], v[4:5], v[32:33], v[18:21]
    ds_read_b64 v[32:33], v79 offset:0
    s_waitcnt lgkmcnt(3)
    v_mfma_f32_4x4x4_16b_bf16 v[18:21], v[4:5], v[26:27], v[18:21]
    ds_read_b64 v[26:27], v78 offset:0
    s_waitcnt lgkmcnt(3)
    v_mfma_f32_4x4x4_16b_bf16 v[18:21], v[4:5], v[28:29], v[18:21]
    ds_read_b64 v[28:29], v77 offset:0
    s_waitcnt lgkmcnt(3)
    v_mfma_f32_4x4x4_16b_bf16 v[18:21], v[4:5], v[30:31], v[18:21]
    ds_read_b64 v[30:31], v76 offset:0
    s_waitcnt lgkmcnt(3)
    v_mfma_f32_4x4x4_16b_bf16 v[18:21], v[4:5], v[32:33], v[18:21]
    ds_read_b64 v[32:33], v75 offset:0
    s_waitcnt lgkmcnt(3)
    v_mfma_f32_4x4x4_16b_bf16 v[18:21], v[4:5], v[26:27], v[18:21]
    ds_read_b64 v[26:27], v74 offset:0
    s_waitcnt lgkmcnt(3)
    v_mfma_f32_4x4x4_16b_bf16 v[18:21], v[4:5], v[28:29], v[18:21]
    ds_read_b64 v[28:29], v73 offset:0
    s_waitcnt lgkmcnt(3)
    v_mfma_f32_4x4x4_16b_bf16 v[18:21], v[4:5], v[30:31], v[18:21]
    ds_read_b64 v[30:31], v72 offset:0
    s_waitcnt lgkmcnt(3)
    v_mfma_f32_4x4x4_16b_bf16 v[18:21], v[4:5], v[32:33], v[18:21]
    ds_read_b64 v[32:33], v71 offset:0
    s_waitcnt lgkmcnt(3)
    v_mfma_f32_4x4x4_16b_bf16 v[18:21], v[4:5], v[26:27], v[18:21]
    ds_read_b64 v[26:27], v70 offset:0
    s_waitcnt lgkmcnt(3)
    v_mfma_f32_4x4x4_16b_bf16 v[18:21], v[4:5], v[28:29], v[18:21]
    ds_read_b64 v[28:29], v69 offset:0
    s_waitcnt lgkmcnt(3)
    v_mfma_f32_4x4x4_16b_bf16 v[18:21], v[4:5], v[30:31], v[18:21]
    ds_read_b64 v[30:31], v68 offset:0
    s_waitcnt lgkmcnt(3)
    v_mfma_f32_4x4x4_16b_bf16 v[18:21], v[4:5], v[32:33], v[18:21]
    ds_read_b64 v[32:33], v67 offset:0
    s_waitcnt lgkmcnt(3)
    v_mfma_f32_4x4x4_16b_bf16 v[18:21], v[4:5], v[26:27], v[18:21]
    ds_read_b64 v[26:27], v66 offset:0
    s_waitcnt lgkmcnt(3)
    v_mfma_f32_4x4x4_16b_bf16 v[18:21], v[4:5], v[28:29], v[18:21]
    ds_read_b64 v[28:29], v65 offset:0
    s_waitcnt lgkmcnt(3)
    v_mfma_f32_4x4x4_16b_bf16 v[18:21], v[4:5], v[30:31], v[18:21]
    ds_read_b64 v[30:31], v64 offset:0
    s_waitcnt lgkmcnt(3)
    v_mfma_f32_4x4x4_16b_bf16 v[18:21], v[4:5], v[32:33], v[18:21]
    ds_read_b64 v[32:33], v63 offset:0
    s_waitcnt lgkmcnt(3)
    v_mfma_f32_4x4x4_16b_bf16 v[18:21], v[4:5], v[26:27], v[18:21]
    ds_read_b64 v[26:27], v62 offset:0
    s_waitcnt lgkmcnt(3)
    v_mfma_f32_4x4x4_16b_bf16 v[18:21], v[4:5], v[28:29], v[18:21]
    ds_read_b64 v[28:29], v61 offset:0
    s_waitcnt lgkmcnt(3)
    v_mfma_f32_4x4x4_16b_bf16 v[18:21], v[4:5], v[30:31], v[18:21]
    ds_read_b64 v[30:31], v60 offset:0
    s_waitcnt lgkmcnt(3)
    v_mfma_f32_4x4x4_16b_bf16 v[18:21], v[4:5], v[32:33], v[18:21]
    ds_read_b64 v[32:33], v59 offset:0
    s_waitcnt lgkmcnt(3)
    v_mfma_f32_4x4x4_16b_bf16 v[18:21], v[4:5], v[26:27], v[18:21]
    ds_read_b64 v[26:27], v58 offset:0
    s_waitcnt lgkmcnt(3)
    v_mfma_f32_4x4x4_16b_bf16 v[18:21], v[4:5], v[28:29], v[18:21]
    ds_read_b64 v[28:29], v57 offset:0
    s_waitcnt lgkmcnt(3)
    v_mfma_f32_4x4x4_16b_bf16 v[18:21], v[4:5], v[30:31], v[18:21]
    ds_read_b64 v[30:31], v56 offset:0
    s_waitcnt lgkmcnt(3)
    v_mfma_f32_4x4x4_16b_bf16 v[18:21], v[4:5], v[32:33], v[18:21]
    ds_read_b64 v[32:33], v55 offset:0
    s_waitcnt lgkmcnt(3)
    v_mfma_f32_4x4x4_16b_bf16 v[18:21], v[4:5], v[26:27], v[18:21]
    ds_read_b64 v[26:27], v54 offset:0
    s_waitcnt lgkmcnt(3)
    v_mfma_f32_4x4x4_16b_bf16 v[18:21], v[4:5], v[28:29], v[18:21]
    ds_read_b64 v[28:29], v53 offset:0
    s_waitcnt lgkmcnt(3)
    v_mfma_f32_4x4x4_16b_bf16 v[18:21], v[4:5], v[30:31], v[18:21]
    ds_read_b64 v[30:31], v52 offset:0
    s_waitcnt lgkmcnt(3)
    v_mfma_f32_4x4x4_16b_bf16 v[18:21], v[4:5], v[32:33], v[18:21]
    ds_read_b64 v[32:33], v51 offset:0
    s_waitcnt lgkmcnt(3)
    v_mfma_f32_4x4x4_16b_bf16 v[18:21], v[4:5], v[26:27], v[18:21]
    ds_read_b64 v[26:27], v50 offset:0
    s_waitcnt lgkmcnt(3)
    v_mfma_f32_4x4x4_16b_bf16 v[18:21], v[4:5], v[28:29], v[18:21]
    ds_read_b64 v[28:29], v49 offset:0
    s_waitcnt lgkmcnt(3)
    v_mfma_f32_4x4x4_16b_bf16 v[18:21], v[4:5], v[30:31], v[18:21]
    ds_read_b64 v[30:31], v48 offset:0
    s_waitcnt lgkmcnt(3)
    v_mfma_f32_4x4x4_16b_bf16 v[18:21], v[4:5], v[32:33], v[18:21]
    ds_read_b64 v[32:33], v47 offset:0
    s_waitcnt lgkmcnt(3)
    v_mfma_f32_4x4x4_16b_bf16 v[18:21], v[4:5], v[26:27], v[18:21]
    ds_read_b64 v[26:27], v46 offset:0
    s_waitcnt lgkmcnt(3)
    v_mfma_f32_4x4x4_16b_bf16 v[18:21], v[4:5], v[28:29], v[18:21]
    ds_read_b64 v[28:29], v45 offset:0
    s_waitcnt lgkmcnt(3)
    v_mfma_f32_4x4x4_16b_bf16 v[18:21], v[4:5], v[30:31], v[18:21]
    ds_read_b64 v[30:31], v44 offset:0
    s_waitcnt lgkmcnt(3)
    v_mfma_f32_4x4x4_16b_bf16 v[18:21], v[4:5], v[32:33], v[18:21]
    ds_read_b64 v[32:33], v43 offset:0
    s_waitcnt lgkmcnt(3)
    v_mfma_f32_4x4x4_16b_bf16 v[18:21], v[4:5], v[26:27], v[18:21]
    ds_read_b64 v[26:27], v42 offset:0
km_1_drain1:
    s_waitcnt lgkmcnt(3)
    v_mfma_f32_4x4x4_16b_bf16 v[18:21], v[4:5], v[28:29], v[18:21]
    s_waitcnt lgkmcnt(2)
    s_cmp_lg_u32 s89, 0
    v_mfma_f32_4x4x4_16b_bf16 v[18:21], v[4:5], v[30:31], v[18:21]
    s_waitcnt lgkmcnt(1)
    s_nop 0
    v_mfma_f32_4x4x4_16b_bf16 v[18:21], v[4:5], v[32:33], v[18:21]
    s_waitcnt lgkmcnt(0)
    s_nop 0
    v_mfma_f32_4x4x4_16b_bf16 v[18:21], v[4:5], v[26:27], v[18:21]
    s_cbranch_scc1 km_1_sp1
    v_add_u32 v24, s43, v9
    s_waitcnt vmcnt(0)
    s_nop 1
    v_mul_f32 v18, v7, v18
    v_mul_f32 v19, v7, v19
    v_mul_f32 v20, v7, v20
    v_mul_f32 v21, v7, v21
    v_mul_f32 v26, v7, v18
    v_mul_f32 v27, v7, v19
    v_mul_f32 v28, v7, v20
    v_mul_f32 v29, v7, v21
    v_cvt_pk_bf16_f32 v22, v26, v27
    v_cvt_pk_bf16_f32 v23, v28, v29
    v_min_u32 v22, -2, v22
    global_store_dwordx2 v9, v[22:23], s[16:17]
km_1_pub1:
    ds_write_b64 v24, v[22:23] offset:40960
    v_cvt_pk_bf16_f32 v16, v18, v19
    v_cvt_pk_bf16_f32 v17, v20, v21
    v_mov_b64 v[18:19], 0
    v_mov_b64 v[20:21], 0
    s_add_u32 s11, s11, 1
    s_add_u32 s74, s74, 2621440
    s_cmp_eq_u32 s74, 7864320
    s_cselect_b32 s74, 0, s74
    s_add_u32 s54, s20, s74
    s_addc_u32 s55, s21, 0
    s_cmp_eq_u32 s11, 6
    s_cselect_b32 s75, 1, s75
    s_cmp_lg_u32 s72, 0
    s_cbranch_scc1 km_1_dly
km_1_fetch0:
    s_add_u32 m0, s84, 40960
    v_add_u32 v24, s84, v1
    buffer_load_dwordx4 v1, s[16:19], s68 offen offset:0 sc1 lds
    buffer_load_dwordx4 v1, s[16:19], s68 offen offset:1024 sc1 lds
    s_add_u32 m0, s85, 40960
    v_add_u32 v25, s85, v1
    buffer_load_dwordx4 v1, s[16:19], s69 offen offset:0 sc1 lds
    buffer_load_dwordx4 v1, s[16:19], s69 offen offset:1024 sc1 lds
    s_waitcnt vmcnt(3)
    ds_read_b128 v[26:29], v24 offset:40960
    s_waitcnt vmcnt(2)
    ds_read_b128 v[30:33], v24 offset:41984
    s_waitcnt lgkmcnt(1)
    v_max_u32 v36, v26, v28
    s_waitcnt vmcnt(1)
    ds_read_b128 v[26:29], v25 offset:40960
    s_waitcnt lgkmcnt(1)
    v_max3_u32 v36, v36, v30, v32
    s_waitcnt vmcnt(0)
    ds_read_b128 v[30:33], v25 offset:41984
    s_waitcnt lgkmcnt(1)
    v_max3_u32 v36, v36, v26, v28
    s_waitcnt lgkmcnt(0)
    v_max3_u32 v36, v36, v30, v32
    v_cmp_eq_u32 vcc, -1, v36
    s_cmp_lg_u32 s72, 0
    s_cbranch_vccnz km_1_again0
    s_cbranch_scc1 km_1_more
km_1_fdone:
km_0_hop:
    s_cmp_eq_u32 s57, 0
    s_barrier
    s_cbranch_scc1 km_0_light
    ds_read_b64 v[26:27], v98 offset:40960
    ds_read_b64 v[28:29], v99 offset:40960
    ds_read_b64 v[30:31], v100 offset:40960
    ds_read_b64 v[32:33], v101 offset:40960
    s_mov_b64 s[16:17], s[58:59]
    s_mov_b64 s[58:59], s[54:55]
    s_cmp_lg_u32 s75, 0
    s_cbranch_scc1 km_0_rs0
    global_store_dwordx2 v8, v[34:35], s[58:59]
    global_store_dwordx2 v9, v[34:35], s[58:59]
km_0_nors0:
    global_store_dwordx4 v0, v[10:13], s[22:23] sc1
    global_store_dwordx4 v2, v[14:17], s[22:23] sc1
    s_cmp_eq_u32 s40, 32
    s_cbranch_scc1 km_0_tw0
    s_waitcnt lgkmcnt(0)
    s_setpc_b64 s[60:61]
km_0_tw0:
    s_waitcnt lgkmcnt(0)
km_0_top0:
    v_lshlrev_b32_sdwa v25, 3, v127 dst_sel:DWORD dst_unused:UNUSED_PAD src0_sel:DWORD src1_sel:WORD_1
    s_waitcnt lgkmcnt(3)
    v_mfma_f32_4x4x4_16b_bf16 v[18:21], v[4:5], v[28:29], v[18:21]
    ds_read_b64 v[28:29], v25 offset:40960
    v_lshlrev_b32_sdwa v24, 3, v127 dst_sel:DWORD dst_unused:UNUSED_PAD src0_sel:DWORD src1_sel:WORD_0
    s_waitcnt lgkmcnt(3)
    v_mfma_f32_4x4x4_16b_bf16 v[18:21], v[4:5], v[30:31], v[18:21]
    ds_read_b64 v[30:31], v24 offset:40960
    v_lshlrev_b32_sdwa v25, 3, v126 dst_sel:DWORD dst_unused:UNUSED_PAD src0_sel:DWORD src1_sel:WORD_1
    s_waitcnt lgkmcnt(3)
    v_mfma_f32_4x4x4_16b_bf16 v[18:21], v[4:5], v[32:33], v[18:21]
    ds_read_b64 v[32:33], v25 offset:40960
    v_lshlrev_b32_sdwa v24, 3, v126 dst_sel:DWORD dst_unused:UNUSED_PAD src0_sel:DWORD src1_sel:WORD_0
    s_waitcnt lgkmcnt(3)
    v_mfma_f32_4x4x4_16b_bf16 v[18:21], v[4:5], v[26:27], v[18:21]
    ds_read_b64 v[26:27], v24 offset:40960
    s_waitcnt lgkmcnt(3)
    v_mfma_f32_4x4x4_16b_bf16 v[18:21], v[4:5], v[28:29], v[18:21]
    ds_read_b64 v[28:29], v125 offset:40960
    s_waitcnt lgkmcnt(3)
    v_mfma_f32_4x4x4_16b_bf16 v[18:21], v[4:5], v[30:31], v[18:21]
    ds_read_b64 v[30:31], v124 offset:40960
    s_waitcnt lgkmcnt(3)
    v_mfma_f32_4x4x4_16b_bf16 v[18:21], v[4:5], v[32:33], v[18:21]
    ds_read_b64 v[32:33], v123 offset:40960
    s_waitcnt lgkmcnt(3)
    v_mfma_f32_4x4x4_16b_bf16 v[18:21], v[4:5], v[26:27], v[18:21]
    ds_read_b64 v[26:27], v122 offset:40960
    s_waitcnt lgkmcnt(3)
    v_mfma_f32_4x4x4_16b_bf16 v[18:21], v[4:5], v[28:29], v[18:21]
    ds_read_b64 v[28:29], v121 offset:40960
    s_waitcnt lgkmcnt(3)
    v_mfma_f32_4x4x4_16b_bf16 v[18:21], v[4:5], v[30:31], v[18:21]
    ds_read_b64 v[30:31], v120 offset:40960
    s_waitcnt lgkmcnt(3)
    v_mfma_f32_4x4x4_16b_bf16 v[18:21], v[4:5], v[32:33], v[18:21]
    ds_read_b64 v[32:33], v119 offset:40960
    s_waitcnt lgkmcnt(3)
    v_mfma_f32_4x4x4_16b_bf16 v[18:21], v[4:5], v[26:27], v[18:21]
    ds_read_b64 v[26:27], v118 offset:40960
    s_waitcnt lgkmcnt(3)
    v_mfma_f32_4x4x4_16b_bf16 v[18:21], v[4:5], v[28:29], v[18:21]
    ds_read_b64 v[28:29], v117 offset:40960
    s_waitcnt lgkmcnt(3)
    v_mfma_f32_4x4x4_16b_bf16 v[18:21], v[4:5], v[30:31], v[18:21]
    ds_read_b64 v[30:31], v116 offset:40960
    s_waitcnt lgkmcnt(3)
    v_mfma_f32_4x4x4_16b_bf16 v[18:21], v[4:5], v[32:33], v[18:21]
    ds_read_b64 v[32:33], v115 offset:40960
    s_waitcnt lgkmcnt(3)
    v_mfma_f32_4x4x4_16b_bf16 v[18:21], v[4:5], v[26:27], v[18:21]
    ds_read_b64 v[26:27], v114 offset:40960
    s_waitcnt lgkmcnt(3)
    v_mfma_f32_4x4x4_16b_bf16 v[18:21], v[4:5], v[28:29], v[18:21]
    ds_read_b64 v[28:29], v113 offset:40960
    s_waitcnt lgkmcnt(3)
    v_mfma_f32_4x4x4_16b_bf16 v[18:21], v[4:5], v[30:31], v[18:21]
    ds_read_b64 v[30:31], v112 offset:40960
    s_waitcnt lgkmcnt(3)
    v_mfma_f32_4x4x4_16b_bf16 v[18:21], v[4:5], v[32:33], v[18:21]
    ds_read_b64 v[32:33], v111 offset:40960
    s_waitcnt lgkmcnt(3)
    v_mfma_f32_4x4x4_16b_bf16 v[18:21], v[4:5], v[26:27], v[18:21]
    ds_read_b64 v[26:27], v110 offset:40960
    s_waitcnt lgkmcnt(3)
    v_mfma_f32_4x4x4_16b_bf16 v[18:21], v[4:5], v[28:29], v[18:21]
    ds_read_b64 v[28:29], v109 offset:40960
    s_waitcnt lgkmcnt(3)
    v_mfma_f32_4x4x4_16b_bf16 v[18:21], v[4:5], v[30:31], v[18:21]
    ds_read_b64 v[30:31], v108 offset:40960
    s_waitcnt lgkmcnt(3)
    v_mfma_f32_4x4x4_16b_bf16 v[18:21], v[4:5], v[32:33], v[18:21]
    ds_read_b64 v[32:33], v107 offset:40960
    s_waitcnt lgkmcnt(3)
    v_mfma_f32_4x4x4_16b_bf16 v[18:21], v[4:5], v[26:27], v[18:21]
    ds_read_b64 v[26:27], v106 offset:40960
    s_waitcnt lgkmcnt(3)
    v_mfma_f32_4x4x4_16b_bf16 v[18:21], v[4:5], v[28:29], v[18:21]
    ds_read_b64 v[28:29], v105 offset:40960
    s_waitcnt lgkmcnt(3)
    v_mfma_f32_4x4x4_16b_bf16 v[18:21], v[4:5], v[30:31], v[18:21]
    ds_read_b64 v[30:31], v104 offset:40960
    s_waitcnt lgkmcnt(3)
    v_mfma_f32_4x4x4_16b_bf16 v[18:21], v[4:5], v[32:33], v[18:21]
    ds_read_b64 v[32:33], v103 offset:40960
    s_waitcnt lgkmcnt(3)
    v_mfma_f32_4x4x4_16b_bf16 v[18:21], v[4:5], v[26:27], v[18:21]
    ds_read_b64 v[26:27], v102 offset:40960
km_0_drain0:
    s_waitcnt lgkmcnt(3)
    v_mfma_f32_4x4x4_16b_bf16 v[18:21], v[4:5], v[28:29], v[18:21]
    s_waitcnt lgkmcnt(2)
    s_cmp_lg_u32 s88, 0
    v_mfma_f32_4x4x4_16b_bf16 v[18:21], v[4:5], v[30:31], v[18:21]
    s_waitcnt lgkmcnt(1)
    s_nop 0
    v_mfma_f32_4x4x4_16b_bf16 v[18:21], v[4:5], v[32:33], v[18:21]
    s_waitcnt lgkmcnt(0)
    s_nop 0
    v_mfma_f32_4x4x4_16b_bf16 v[18:21], v[4:5], v[26:27], v[18:21]
    s_cbranch_scc1 km_0_sp0
    v_add_u32 v24, s43, v8
    s_nop 2
    v_mov_b32 v26, v18
    v_mov_b32 v27, v19
    v_mov_b32 v28, v20
    v_mov_b32 v29, v21
    v_permlane32_swap_b32 v18, v26
    v_permlane32_swap_b32 v19, v27
    v_permlane32_swap_b32 v20, v28
    v_permlane32_swap_b32 v21, v29
    v_add_f32 v18, v18, v26
    v_add_f32 v19, v19, v27
    v_add_f32 v20, v20, v28
    v_add_f32 v21, v21, v29
    v_mul_f32 v18, v6, v18
    v_mul_f32 v19, v6, v19
    v_mul_f32 v20, v6, v20
    v_mul_f32 v21, v6, v21
    v_mul_f32 v26, v6, v18
    v_mul_f32 v27, v6, v19
    v_mul_f32 v28, v6, v20
    v_mul_f32 v29, v6, v21
    v_cvt_pk_bf16_f32 v22, v26, v27
    v_cvt_pk_bf16_f32 v23, v28, v29
    v_min_u32 v22, -2, v22
    global_store_dwordx2 v8, v[22:23], s[16:17]
km_0_pub0:
    ds_write_b64 v24, v[22:23] offset:0
    v_cvt_pk_bf16_f32 v10, v18, v19
    v_cvt_pk_bf16_f32 v11, v20, v21
    v_mov_b64 v[18:19], 0
    v_mov_b64 v[20:21], 0
km_0_full:
    ds_read_b64 v[26:27], v38 offset:40960
    ds_read_b64 v[28:29], v39 offset:40960
    ds_read_b64 v[30:31], v40 offset:40960
    ds_read_b64 v[32:33], v41 offset:40960
km_0_go1:
    s_cmp_eq_u32 s41, 64
    s_cbranch_scc1 km_0_tw1
    s_waitcnt lgkmcnt(0)
    s_setpc_b64 s[62:63]
km_0_light:
    ds_read_b64 v[26:27], v38 offset:40960
    ds_read_b64 v[28:29], v39 offset:40960
    ds_read_b64 v[30:31], v40 offset:40960
    ds_read_b64 v[32:33], v41 offset:40960
    s_mov_b64 s[16:17], s[58:59]
    s_mov_b64 s[58:59], s[54:55]
    s_cmp_lg_u32 s75, 0
    s_cbranch_scc1 km_0_rs1
    global_store_dwordx2 v9, v[34:35], s[58:59]
km_0_nors1:
    global_store_dwordx4 v2, v[14:17], s[22:23] sc1
    s_cmp_lg_u32 s10, 15
    s_cbranch_scc1 km_0_go1
    s_lshl_b32 s12, s9, 5
    s_add_u32 s12, s12, s8
    s_cmp_lg_u32 s11, 2
    s_cbranch_scc1 km_0_an3
    s_min_u32 s12, s12, 249
    s_mul_i32 s12, s12, 10240
    v_lshl_add_u32 v24, v1, 3, s12
    global_load_dword v37, v24, s[6:7]
    v_add_u32 v24, 8192, v24
    s_mov_b64 exec, 0xffff
    global_load_dword v37, v24, s[6:7]
    s_and_b32 s12, s29, 31
    s_mul_i32 s12, s12, 2176
    s_add_u32 s12, s12, 163840
    s_mov_b64 exec, 0x3ffff
    v_lshl_add_u32 v24, v1, 3, s12
    global_load_dword v37, v24, s[4:5] sc1
    s_mov_b64 exec, -1
    s_branch km_0_go1
km_0_an3:
    s_branch km_0_go1
km_0_tw1:
    s_waitcnt lgkmcnt(0)
km_0_top1:
    v_lshlrev_b32_sdwa v25, 3, v97 dst_sel:DWORD dst_unused:UNUSED_PAD src0_sel:DWORD src1_sel:WORD_1
    s_waitcnt lgkmcnt(3)
    v_mfma_f32_4x4x4_16b_bf16 v[18:21], v[4:5], v[28:29], v[18:21]
    ds_read_b64 v[28:29], v25 offset:40960
    v_lshlrev_b32_sdwa v24, 3, v97 dst_sel:DWORD dst_unused:UNUSED_PAD src0_sel:DWORD src1_sel:WORD_0
    s_waitcnt lgkmcnt(3)
    v_mfma_f32_4x4x4_16b_bf16 v[18:21], v[4:5], v[30:31], v[18:21]
    ds_read_b64 v[30:31], v24 offset:40960
    v_lshlrev_b32_sdwa v25, 3, v96 dst_sel:DWORD dst_unused:UNUSED_PAD src0_sel:DWORD src1_sel:WORD_1
    s_waitcnt lgkmcnt(3)
    v_mfma_f32_4x4x4_16b_bf16 v[18:21], v[4:5], v[32:33], v[18:21]
    ds_read_b64 v[32:33], v25 offset:40960
    v_lshlrev_b32_sdwa v24, 3, v96 dst_sel:DWORD dst_unused:UNUSED_PAD src0_sel:DWORD src1_sel:WORD_0
    s_waitcnt lgkmcnt(3)
    v_mfma_f32_4x4x4_16b_bf16 v[18:21], v[4:5], v[26:27], v[18:21]
    ds_read_b64 v[26:27], v24 offset:40960
    v_lshlrev_b32_sdwa v25, 3, v95 dst_sel:DWORD dst_unused:UNUSED_PAD src0_sel:DWORD src1_sel:WORD_1
    s_waitcnt lgkmcnt(3)
    v_mfma_f32_4x4x4_16b_bf16 v[18:21], v[4:5], v[28:29], v[18:21]
    ds_read_b64 v[28:29], v25 offset:40960
    v_lshlrev_b32_sdwa v24, 3, v95 dst_sel:DWORD dst_unused:UNUSED_PAD src0_sel:DWORD src1_sel:WORD_0
    s_waitcnt lgkmcnt(3)
    v_mfma_f32_4x4x4_16b_bf16 v[18:21], v[4:5], v[30:31], v[18:21]
    ds_read_b64 v[30:31], v24 offset:40960
    v_lshlrev_b32_sdwa v25, 3, v94 dst_sel:DWORD dst_unused:UNUSED_PAD src0_sel:DWORD src1_sel:WORD_1
    s_waitcnt lgkmcnt(3)
    v_mfma_f32_4x4x4_16b_bf16 v[18:21], v[4:5], v[32:33], v[18:21]
    ds_read_b64 v[32:33], v25 offset:40960
    v_lshlrev_b32_sdwa v24, 3, v94 dst_sel:DWORD dst_unused:UNUSED_PAD src0_sel:DWORD src1_sel:WORD_0
    s_waitcnt lgkmcnt(3)
    v_mfma_f32_4x4x4_16b_bf16 v[18:21], v[4:5], v[26:27], v[18:21]
    ds_read_b64 v[26:27], v24 offset:40960
    s_waitcnt lgkmcnt(3)
    v_mfma_f32_4x4x4_16b_bf16 v[18:21], v[4:5], v[28:29], v[18:21]
    ds_read_b64 v[28:29], v93 offset:40960
    s_waitcnt lgkmcnt(3)
    v_mfma_f32_4x4x4_16b_bf16 v[18:21], v[4:5], v[30:31], v[18:21]
    ds_read_b64 v[30:31], v92 offset:40960
    s_waitcnt lgkmcnt(3)
    v_mfma_f32_4x4x4_16b_bf16 v[18:21], v[4:5], v[32:33], v[18:21]
    ds_read_b64 v[32:33], v91 offset:40960
    s_waitcnt lgkmcnt(3)
    v_mfma_f32_4x4x4_16b_bf16 v[18:21], v[4:5], v[26:27], v[18:21]
    ds_read_b64 v[26:27], v90 offset:40960
    s_waitcnt lgkmcnt(3)
    v_mfma_f32_4x4x4_16b_bf16 v[18:21], v[4:5], v[28:29], v[18:21]
    ds_read_b64 v[28:29], v89 offset:40960
    s_waitcnt lgkmcnt(3)
    v_mfma_f32_4x4x4_16b_bf16 v[18:21], v[4:5], v[30:31], v[18:21]
    ds_read_b64 v[30:31], v88 offset:40960
    s_waitcnt lgkmcnt(3)
    v_mfma_f32_4x4x4_16b_bf16 v[18:21], v[4:5], v[32:33], v[18:21]
    ds_read_b64 v[32:33], v87 offset:40960
    s_waitcnt lgkmcnt(3)
    v_mfma_f32_4x4x4_16b_bf16 v[18:21], v[4:5], v[26:27], v[18:21]
    ds_read_b64 v[26:27], v86 offset:40960
    s_waitcnt lgkmcnt(3)
    v_mfma_f32_4x4x4_16b_bf16 v[18:21], v[4:5], v[28:29], v[18:21]
    ds_read_b64 v[28:29], v85 offset:40960
    s_waitcnt lgkmcnt(3)
    v_mfma_f32_4x4x4_16b_bf16 v[18:21], v[4:5], v[30:31], v[18:21]
    ds_read_b64 v[30:31], v84 offset:40960
    s_waitcnt lgkmcnt(3)
    v_mfma_f32_4x4x4_16b_bf16 v[18:21], v[4:5], v[32:33], v[18:21]
    ds_read_b64 v[32:33], v83 offset:40960
    s_waitcnt lgkmcnt(3)
    v_mfma_f32_4x4x4_16b_bf16 v[18:21], v[4:5], v[26:27], v[18:21]
    ds_read_b64 v[26:27], v82 offset:40960
    s_waitcnt lgkmcnt(3)
    v_mfma_f32_4x4x4_16b_bf16 v[18:21], v[4:5], v[28:29], v[18:21]
    ds_read_b64 v[28:29], v81 offset:40960
    s_waitcnt lgkmcnt(3)
    v_mfma_f32_4x4x4_16b_bf16 v[18:21], v[4:5], v[30:31], v[18:21]
    ds_read_b64 v[30:31], v80 offset:40960
    s_waitcnt lgkmcnt(3)
    v_mfma_f32_4x4x4_16b_bf16 v[18:21], v[4:5], v[32:33], v[18:21]
    ds_read_b64 v[32:33], v79 offset:40960
    s_waitcnt lgkmcnt(3)
    v_mfma_f32_4x4x4_16b_bf16 v[18:21], v[4:5], v[26:27], v[18:21]
    ds_read_b64 v[26:27], v78 offset:40960
    s_waitcnt lgkmcnt(3)
    v_mfma_f32_4x4x4_16b_bf16 v[18:21], v[4:5], v[28:29], v[18:21]
    ds_read_b64 v[28:29], v77 offset:40960
    s_waitcnt lgkmcnt(3)
    v_mfma_f32_4x4x4_16b_bf16 v[18:21], v[4:5], v[30:31], v[18:21]
    ds_read_b64 v[30:31], v76 offset:40960
    s_waitcnt lgkmcnt(3)
    v_mfma_f32_4x4x4_16b_bf16 v[18:21], v[4:5], v[32:33], v[18:21]
    ds_read_b64 v[32:33], v75 offset:40960
    s_waitcnt lgkmcnt(3)
    v_mfma_f32_4x4x4_16b_bf16 v[18:21], v[4:5], v[26:27], v[18:21]
    ds_read_b64 v[26:27], v74 offset:40960
    s_waitcnt lgkmcnt(3)
    v_mfma_f32_4x4x4_16b_bf16 v[18:21], v[4:5], v[28:29], v[18:21]
    ds_read_b64 v[28:29], v73 offset:40960
    s_waitcnt lgkmcnt(3)
    v_mfma_f32_4x4x4_16b_bf16 v[18:21], v[4:5], v[30:31], v[18:21]
    ds_read_b64 v[30:31], v72 offset:40960
    s_waitcnt lgkmcnt(3)
    v_mfma_f32_4x4x4_16b_bf16 v[18:21], v[4:5], v[32:33], v[18:21]
    ds_read_b64 v[32:33], v71 offset:40960
    s_waitcnt lgkmcnt(3)
    v_mfma_f32_4x4x4_16b_bf16 v[18:21], v[4:5], v[26:27], v[18:21]
    ds_read_b64 v[26:27], v70 offset:40960
    s_waitcnt lgkmcnt(3)
    v_mfma_f32_4x4x4_16b_bf16 v[18:21], v[4:5], v[28:29], v[18:21]
    ds_read_b64 v[28:29], v69 offset:40960
    s_waitcnt lgkmcnt(3)
    v_mfma_f32_4x4x4_16b_bf16 v[18:21], v[4:5], v[30:31], v[18:21]
    ds_read_b64 v[30:31], v68 offset:40960
    s_waitcnt lgkmcnt(3)
    v_mfma_f32_4x4x4_16b_bf16 v[18:21], v[4:5], v[32:33], v[18:21]
    ds_read_b64 v[32:33], v67 offset:40960
    s_waitcnt lgkmcnt(3)
    v_mfma_f32_4x4x4_16b_bf16 v[18:21], v[4:5], v[26:27], v[18:21]
    ds_read_b64 v[26:27], v66 offset:40960
    s_waitcnt lgkmcnt(3)
    v_mfma_f32_4x4x4_16b_bf16 v[18:21], v[4:5], v[28:29], v[18:21]
    ds_read_b64 v[28:29], v65 offset:40960
    s_waitcnt lgkmcnt(3)
    v_mfma_f32_4x4x4_16b_bf16 v[18:21], v[4:5], v[30:31], v[18:21]
    ds_read_b64 v[30:31], v64 offset:40960
    s_waitcnt lgkmcnt(3)
    v_mfma_f32_4x4x4_16b_bf16 v[18:21], v[4:5], v[32:33], v[18:21]
    ds_read_b64 v[32:33], v63 offset:40960
    s_waitcnt lgkmcnt(3)
    v_mfma_f32_4x4x4_16b_bf16 v[18:21], v[4:5], v[26:27], v[18:21]
    ds_read_b64 v[26:27], v62 offset:40960
    s_waitcnt lgkmcnt(3)
    v_mfma_f32_4x4x4_16b_bf16 v[18:21], v[4:5], v[28:29], v[18:21]
    ds_read_b64 v[28:29], v61 offset:40960
    s_waitcnt lgkmcnt(3)
    v_mfma_f32_4x4x4_16b_bf16 v[18:21], v[4:5], v[30:31], v[18:21]
    ds_read_b64 v[30:31], v60 offset:40960
    s_waitcnt lgkmcnt(3)
    v_mfma_f32_4x4x4_16b_bf16 v[18:21], v[4:5], v[32:33], v[18:21]
    ds_read_b64 v[32:33], v59 offset:40960
    s_waitcnt lgkmcnt(3)
    v_mfma_f32_4x4x4_16b_bf16 v[18:21], v[4:5], v[26:27], v[18:21]
    ds_read_b64 v[26:27], v58 offset:40960
    s_waitcnt lgkmcnt(3)
    v_mfma_f32_4x4x4_16b_bf16 v[18:21], v[4:5], v[28:29], v[18:21]
    ds_read_b64 v[28:29], v57 offset:40960
    s_waitcnt lgkmcnt(3)
    v_mfma_f32_4x4x4_16b_bf16 v[18:21], v[4:5], v[30:31], v[18:21]
    ds_read_b64 v[30:31], v56 offset:40960
    s_waitcnt lgkmcnt(3)
    v_mfma_f32_4x4x4_16b_bf16 v[18:21], v[4:5], v[32:33], v[18:21]
    ds_read_b64 v[32:33], v55 offset:40960
    s_waitcnt lgkmcnt(3)
    v_mfma_f32_4x4x4_16b_bf16 v[18:21], v[4:5], v[26:27], v[18:21]
    ds_read_b64 v[26:27], v54 offset:40960
    s_waitcnt lgkmcnt(3)
    v_mfma_f32_4x4x4_16b_bf16 v[18:21], v[4:5], v[28:29], v[18:21]
    ds_read_b64 v[28:29], v53 offset:40960
    s_waitcnt lgkmcnt(3)
    v_mfma_f32_4x4x4_16b_bf16 v[18:21], v[4:5], v[30:31], v[18:21]
    ds_read_b64 v[30:31], v52 offset:40960
    s_waitcnt lgkmcnt(3)
    v_mfma_f32_4x4x4_16b_bf16 v[18:21], v[4:5], v[32:33], v[18:21]
    ds_read_b64 v[32:33], v51 offset:40960
    s_waitcnt lgkmcnt(3)
    v_mfma_f32_4x4x4_16b_bf16 v[18:21], v[4:5], v[26:27], v[18:21]
    ds_read_b64 v[26:27], v50 offset:40960
    s_waitcnt lgkmcnt(3)
    v_mfma_f32_4x4x4_16b_bf16 v[18:21], v[4:5], v[28:29], v[18:21]
    ds_read_b64 v[28:29], v49 offset:40960
    s_waitcnt lgkmcnt(3)
    v_mfma_f32_4x4x4_16b_bf16 v[18:21], v[4:5], v[30:31], v[18:21]
    ds_read_b64 v[30:31], v48 offset:40960
    s_waitcnt lgkmcnt(3)
    v_mfma_f32_4x4x4_16b_bf16 v[18:21], v[4:5], v[32:33], v[18:21]
    ds_read_b64 v[32:33], v47 offset:40960
    s_waitcnt lgkmcnt(3)
    v_mfma_f32_4x4x4_16b_bf16 v[18:21], v[4:5], v[26:27], v[18:21]
    ds_read_b64 v[26:27], v46 offset:40960
    s_waitcnt lgkmcnt(3)
    v_mfma_f32_4x4x4_16b_bf16 v[18:21], v[4:5], v[28:29], v[18:21]
    ds_read_b64 v[28:29], v45 offset:40960
    s_waitcnt lgkmcnt(3)
    v_mfma_f32_4x4x4_16b_bf16 v[18:21], v[4:5], v[30:31], v[18:21]
    ds_read_b64 v[30:31], v44 offset:40960
    s_waitcnt lgkmcnt(3)
    v_mfma_f32_4x4x4_16b_bf16 v[18:21], v[4:5], v[32:33], v[18:21]
    ds_read_b64 v[32:33], v43 offset:40960
    s_waitcnt lgkmcnt(3)
    v_mfma_f32_4x4x4_16b_bf16 v[18:21], v[4:5], v[26:27], v[18:21]
    ds_read_b64 v[26:27], v42 offset:40960
km_0_drain1:
    s_waitcnt lgkmcnt(3)
    v_mfma_f32_4x4x4_16b_bf16 v[18:21], v[4:5], v[28:29], v[18:21]
    s_waitcnt lgkmcnt(2)
    s_cmp_lg_u32 s89, 0
    v_mfma_f32_4x4x4_16b_bf16 v[18:21], v[4:5], v[30:31], v[18:21]
    s_waitcnt lgkmcnt(1)
    s_nop 0
    v_mfma_f32_4x4x4_16b_bf16 v[18:21], v[4:5], v[32:33], v[18:21]
    s_waitcnt lgkmcnt(0)
    s_nop 0
    v_mfma_f32_4x4x4_16b_bf16 v[18:21], v[4:5], v[26:27], v[18:21]
    s_cbranch_scc1 km_0_sp1
    v_add_u32 v24, s43, v9
    s_waitcnt vmcnt(1)
    s_nop 1
    v_mul_f32 v18, v7, v18
    v_mul_f32 v19, v7, v19
    v_mul_f32 v20, v7, v20
    v_mul_f32 v21, v7, v21
    v_mul_f32 v26, v7, v18
    v_mul_f32 v27, v7, v19
    v_mul_f32 v28, v7, v20
    v_mul_f32 v29, v7, v21
    v_cvt_pk_bf16_f32 v22, v26, v27
    v_cvt_pk_bf16_f32 v23, v28, v29
    v_min_u32 v22, -2, v22
    global_store_dwordx2 v9, v[22:23], s[16:17]
km_0_pub1:
    ds_write_b64 v24, v[22:23] offset:0
    v_cvt_pk_bf16_f32 v14, v18, v19
    v_cvt_pk_bf16_f32 v15, v20, v21
    v_mov_b64 v[18:19], 0
    v_mov_b64 v[20:21], 0
    s_add_u32 s11, s11, 1
    s_add_u32 s74, s74, 2621440
    s_cmp_eq_u32 s74, 7864320
    s_cselect_b32 s74, 0, s74
    s_add_u32 s54, s20, s74
    s_addc_u32 s55, s21, 0
    s_add_u32 s22, s22, 4096
    s_addc_u32 s23, s23, 0
    s_cmp_eq_u32 s11, 7
    s_cselect_b64 s[88:89], -1, s[88:89]
    s_cmp_lg_u32 s72, 0
    s_cbranch_scc1 km_0_dly
km_0_fetch0:
    s_add_u32 m0, s84, 0
    v_add_u32 v24, s84, v1
    buffer_load_dwordx4 v1, s[16:19], s68 offen offset:0 sc1 lds
    buffer_load_dwordx4 v1, s[16:19], s68 offen offset:1024 sc1 lds
    s_add_u32 m0, s85, 0
    v_add_u32 v25, s85, v1
    buffer_load_dwordx4 v1, s[16:19], s69 offen offset:0 sc1 lds
    buffer_load_dwordx4 v1, s[16:19], s69 offen offset:1024 sc1 lds
    s_waitcnt vmcnt(3)
    ds_read_b128 v[26:29], v24 offset:0
    s_waitcnt vmcnt(2)
    ds_read_b128 v[30:33], v24 offset:1024
    s_waitcnt lgkmcnt(1)
    v_max_u32 v36, v26, v28
    s_waitcnt vmcnt(1)
    ds_read_b128 v[26:29], v25 offset:0
    s_waitcnt lgkmcnt(1)
    v_max3_u32 v36, v36, v30, v32
    s_waitcnt vmcnt(0)
    ds_read_b128 v[30:33], v25 offset:1024
    s_waitcnt lgkmcnt(1)
    v_max3_u32 v36, v36, v26, v28
    s_waitcnt lgkmcnt(0)
    v_max3_u32 v36, v36, v30, v32
    v_cmp_eq_u32 vcc, -1, v36
    s_cmp_lg_u32 s72, 0
    s_cbranch_vccnz km_0_again0
    s_cbranch_scc1 km_0_more
km_0_fdone:
    s_branch km_1_hop
km_done:
    s_lshl_b32 s14, s9, 5
    s_add_u32 s14, s14, s8
    s_add_u32 s52, s4, 163840
    s_addc_u32 s53, s5, 0
    s_add_u32 s16, s4, 12582912
    s_addc_u32 s17, s5, 0
    s_mov_b32 s18, 20971520
    s_lshl_b32 s12, s47, 1
    s_and_b32 s13, s10, 1
    s_add_u32 s12, s12, s13
    s_lshl_b32 s12, s12, 7
    s_lshl_b32 s13, s46, 8
    v_lshl_add_u32 v24, v1, 3, s13
    v_writelane_b32 v24, s12, 2
    s_lshl_b32 s12, s8, 2
    s_add_u32 s12, s12, 270336
    v_add_u32 v24, s12, v24
    v_mov_b32 v25, s90
    s_lshl_b32 s12, s57, 2
    s_or_b32 exec_lo, s12, 3
    s_mov_b32 exec_hi, 0
    s_waitcnt vmcnt(0)
    global_store_dword v24, v25, s[4:5] sc1
    s_mov_b64 exec, -1
    s_cmp_ge_u32 s14, 250
    s_cbranch_scc1 km_fin
    s_cmp_lg_u32 s10, 0
    s_cbranch_scc1 km_b7
    v_lshrrev_b32 v24, 2, v1
    v_and_b32 v24, 28, v24
    v_add_u32 v24, 77824, v24
    v_mov_b32 v25, 0
    ds_write_b32 v24, v25
    s_lshl_b32 s12, s9, 7
    s_add_u32 s12, s12, 266240
    v_bfe_u32 v24, v1, 4, 5
    v_lshl_add_u32 v24, v24, 2, s12
km_p7:
    global_load_dword v25, v24, s[4:5] sc1
    s_waitcnt vmcnt(0)
    v_cmp_ne_u32 vcc, s90, v25
    s_cbranch_vccz km_p7_d
    s_sleep 4
    s_branch km_p7
km_p7_d:
km_b7:
    s_and_b32 s51, s10, 3
    s_lshr_b32 s50, s10, 2
    v_mov_b32 v22, 77824
    v_mov_b32 v23, 1
    s_lshl_b32 s12, s10, 12
    v_add_u32 v24, s12, v1
    s_add_u32 m0, s12, 40960
    s_waitcnt lgkmcnt(0)
    s_barrier
    s_cmp_gt_u32 s10, 8
    s_cbranch_scc1 km_wf
    global_load_lds_dwordx4 v24, s[52:53] offset:0 sc1
    global_load_lds_dwordx4 v24, s[52:53] offset:1024 sc1
    global_load_lds_dwordx4 v24, s[52:53] offset:2048 sc1
    global_load_lds_dwordx4 v24, s[52:53] offset:3072 sc1
    s_cmp_lt_u32 s10, 8
    s_cbranch_scc1 km_wd
km_wf:
    s_add_u32 m0, m0, 49152
    v_add_u32 v24, 4096, v24
    global_load_lds_dwordx4 v24, s[52:53] offset:0 sc1
    global_load_lds_dwordx4 v24, s[52:53] offset:1024 sc1
    global_load_lds_dwordx4 v24, s[52:53] offset:2048 sc1
    global_load_lds_dwordx4 v24, s[52:53] offset:3072 sc1
km_wd:
    s_cmp_lg_u32 s10, 0
    s_cbranch_scc1 km_ws
    s_mov_b32 m0, 77856
    v_mov_b32 v24, 69632
    s_mov_b64 exec, 1
    global_load_lds_dword v24, s[52:53] sc1
    s_mov_b64 exec, -1
km_ws:
    s_barrier
    s_cmp_ge_u32 s10, 8
    s_cselect_b32 s12, 3, s51
    s_cmp_eq_u32 s12, 3
    s_cbranch_scc1 km_lt
    s_lshl_b32 s12, s51, 5
    v_xor_b32 v36, s12, v1
    s_and_b32 s12, s51, 2
    s_add_u32 s12, s12, s51
    s_mul_i32 s12, s12, 20480
    s_lshl_b32 s13, s50, 12
    s_add_u32 m0, s12, s13
    s_mul_i32 s12, s14, 5
    s_add_u32 s12, s12, s50
    s_lshl_b32 s12, s12, 2
    s_add_u32 s12, s12, s51
    s_lshl_b32 s12, s12, 12
    buffer_load_dwordx4 v36, s[16:19], s12 offen offset:0 sc1 lds
    buffer_load_dwordx4 v36, s[16:19], s12 offen offset:1024 sc1 lds
    buffer_load_dwordx4 v36, s[16:19], s12 offen offset:2048 sc1 lds
    buffer_load_dwordx4 v36, s[16:19], s12 offen offset:3072 sc1 lds
    s_cmp_lg_u32 s51, 0
    s_cbranch_scc1 km_xp_1
    s_lshr_b32 s12, s12, 3
    v_add_u32 v36, s12, v1
    global_load_dwordx4 v[28:31], v36, s[6:7]
    global_load_dwordx4 v[32:35], v36, s[6:7] offset:1024
    v_and_b32 v24, 0xf0, v1
    v_lshlrev_b32 v24, 4, v24
    v_lshrrev_b32 v25, 4, v1
    v_and_b32 v25, 0x30, v25
    v_add3_u32 v24, v24, v25, s13
    s_waitcnt vmcnt(0)
    ds_write_b64 v24, v[28:29]
    ds_write_b64 v24, v[30:31] offset:128
    ds_write_b64 v24, v[32:33] offset:64
    ds_write_b64 v24, v[34:35] offset:192
km_xp_1:
    v_lshrrev_b32 v0, 4, v1
    s_mov_b32 s34, 0xaaaaaaaa
    s_mov_b32 s35, 0xaaaaaaaa
    s_mov_b32 s36, 0xcccccccc
    s_mov_b32 s37, 0xcccccccc
    s_mov_b32 s38, 0x00f0000f
    s_mov_b32 s39, 0xf0000f00
    s_mov_b32 s42, 0x00ff00ff
    s_mov_b32 s43, 0xff00ff00
    s_mov_b32 s41, 0x3c000000
    v_cndmask_b32 v11, 0, -1, s[42:43]
    v_mov_b32 v9, 0x3f80
    v_mov_b32 v10, 0x3f800000
    v_cndmask_b32 v9, v9, v10, s[34:35]
    v_cndmask_b32 v9, 0, v9, s[38:39]
    v_cndmask_b32 v62, v9, 0, s[36:37]
    v_cndmask_b32 v63, 0, v9, s[36:37]
    v_lshrrev_b32 v9, 4, v0
    v_bfe_u32 v10, v0, 1, 2
    s_and_b32 s12, s10, 3
    v_xor_b32 v4, s12, v10
    v_lshlrev_b32 v4, 5, v4
    v_lshl_add_u32 v4, v9, 7, v4
    v_and_b32 v6, 2, v10
    v_add_u32 v10, v10, v6
    v_mul_u32_u24 v10, 20480, v10
    v_add_u32 v4, v4, v10
    v_and_b32 v10, 1, v0
    v_lshl_add_u32 v4, v10, 3, v4
    v_bfe_u32 v10, v0, 3, 1
    v_lshl_add_u32 v4, v10, 4, v4
    s_lshr_b32 s12, s10, 2
    s_lshl_b32 s12, s12, 12
    v_add_u32 v4, s12, v4
    v_and_b32 v5, 15, v0
    v_lshlrev_b32 v2, 1, v5
    v_lshl_add_u32 v2, v9, 7, v2
    s_lshl_b32 s12, s10, 9
    s_add_u32 s12, s12, 155648
    v_lshl_add_u32 v5, v5, 2, s12
    v_lshl_add_u32 v6, v9, 4, s12
    v_lshrrev_b32 v7, 2, v0
    v_lshl_add_u32 v7, v7, 2, s12
    s_mov_b32 s33, 0x3727c5ac
    s_mov_b32 s44, s12
    v_add_u32 v2, s12, v2
    v_and_b32 v0, 31, v0
    v_lshl_add_u32 v0, v0, 2, s12
    s_mul_i32 s12, s14, 20
    s_add_u32 s12, s12, s10
    s_lshl_b32 s12, s12, 9
    s_add_u32 s30, s30, s12
    s_addc_u32 s31, s31, 0
    s_mov_b32 s32, s10
    s_waitcnt vmcnt(4)
    s_mov_b64 exec, 1
    ds_add_u32 v22, v23 offset:20
    s_mov_b64 exec, -1
    s_branch km_l5
km_lt:
    v_lshrrev_b32 v0, 4, v1
    s_mov_b32 s34, 0xaaaaaaaa
    s_mov_b32 s35, 0xaaaaaaaa
    s_mov_b32 s36, 0xcccccccc
    s_mov_b32 s37, 0xcccccccc
    s_mov_b32 s38, 0x00f0000f
    s_mov_b32 s39, 0xf0000f00
    s_mov_b32 s42, 0x00ff00ff
    s_mov_b32 s43, 0xff00ff00
    s_mov_b32 s41, 0x3c000000
    v_cndmask_b32 v11, 0, -1, s[42:43]
    v_mov_b32 v9, 0x3f80
    v_mov_b32 v10, 0x3f800000
    v_cndmask_b32 v9, v9, v10, s[34:35]
    v_cndmask_b32 v9, 0, v9, s[38:39]
    v_cndmask_b32 v62, v9, 0, s[36:37]
    v_cndmask_b32 v63, 0, v9, s[36:37]
    v_lshrrev_b32 v9, 4, v0
    v_bfe_u32 v10, v0, 1, 2
    s_and_b32 s12, s10, 3
    v_xor_b32 v4, s12, v10
    v_lshlrev_b32 v4, 5, v4
    v_lshl_add_u32 v4, v9, 7, v4
    v_and_b32 v6, 2, v10
    v_add_u32 v10, v10, v6
    v_mul_u32_u24 v10, 20480, v10
    v_add_u32 v4, v4, v10
    v_and_b32 v10, 1, v0
    v_lshl_add_u32 v4, v10, 3, v4
    v_bfe_u32 v10, v0, 3, 1
    v_lshl_add_u32 v4, v10, 4, v4
    s_lshr_b32 s12, s10, 2
    s_lshl_b32 s12, s12, 12
    v_add_u32 v4, s12, v4
    v_and_b32 v5, 15, v0
    v_lshlrev_b32 v2, 1, v5
    v_lshl_add_u32 v2, v9, 7, v2
    s_lshl_b32 s12, s10, 9
    s_add_u32 s12, s12, 155648
    v_lshl_add_u32 v5, v5, 2, s12
    v_lshl_add_u32 v6, v9, 4, s12
    v_lshrrev_b32 v7, 2, v0
    v_lshl_add_u32 v7, v7, 2, s12
    s_mov_b32 s33, 0x3727c5ac
    s_mov_b32 s44, s12
    v_add_u32 v2, s12, v2
    v_and_b32 v0, 31, v0
    v_lshl_add_u32 v0, v0, 2, s12
    s_mul_i32 s12, s14, 20
    s_add_u32 s12, s12, s10
    s_lshl_b32 s12, s12, 9
    s_add_u32 s30, s30, s12
    s_addc_u32 s31, s31, 0
    s_mov_b32 s32, s10
    s_waitcnt vmcnt(0)
    s_mov_b64 exec, 1
    ds_add_u32 v22, v23 offset:20
    s_mov_b64 exec, -1
    s_cmp_lt_u32 s10, 8
    s_cbranch_scc1 km_l3
km_aw0:
    ds_read_b32 v24, v22 offset:0
    s_waitcnt lgkmcnt(0)
    v_readfirstlane_b32 s12, v24
    s_cmp_eq_u32 s12, 4
    s_cbranch_scc1 km_aw0_d
    s_sleep 1
    s_branch km_aw0
km_aw0_d:
km_l2:
    s_cmp_lg_u32 s51, 3
    s_cbranch_scc1 km_l4
km_l3:
    s_mul_i32 s12, s14, 5
    s_add_u32 s12, s12, s50
    s_lshr_b32 s12, s12, 2
    s_lshl_b32 s12, s12, 7
    s_add_u32 s12, s12, 270336
    v_bfe_u32 v24, v1, 4, 5
    v_lshl_add_u32 v24, v24, 2, s12
km_p9:
    global_load_dword v25, v24, s[4:5] sc1
    s_waitcnt vmcnt(0)
    v_cmp_ne_u32 vcc, s90, v25
    s_cbranch_vccz km_p9_d
    s_sleep 4
    s_branch km_p9
km_p9_d:
km_l4:
    s_lshl_b32 s12, s51, 5
    v_xor_b32 v36, s12, v1
    s_and_b32 s12, s51, 2
    s_add_u32 s12, s12, s51
    s_mul_i32 s12, s12, 20480
    s_lshl_b32 s13, s50, 12
    s_add_u32 m0, s12, s13
    s_mul_i32 s12, s14, 5
    s_add_u32 s12, s12, s50
    s_lshl_b32 s12, s12, 2
    s_add_u32 s12, s12, s51
    s_lshl_b32 s12, s12, 12
    buffer_load_dwordx4 v36, s[16:19], s12 offen offset:0 sc1 lds
    buffer_load_dwordx4 v36, s[16:19], s12 offen offset:1024 sc1 lds
    buffer_load_dwordx4 v36, s[16:19], s12 offen offset:2048 sc1 lds
    buffer_load_dwordx4 v36, s[16:19], s12 offen offset:3072 sc1 lds
    s_cmp_lg_u32 s51, 0
    s_cbranch_scc1 km_xp_2
    s_lshr_b32 s12, s12, 3
    v_add_u32 v36, s12, v1
    global_load_dwordx4 v[28:31], v36, s[6:7]
    global_load_dwordx4 v[32:35], v36, s[6:7] offset:1024
    v_and_b32 v24, 0xf0, v1
    v_lshlrev_b32 v24, 4, v24
    v_lshrrev_b32 v25, 4, v1
    v_and_b32 v25, 0x30, v25
    v_add3_u32 v24, v24, v25, s13
    s_waitcnt vmcnt(0)
    ds_write_b64 v24, v[28:29]
    ds_write_b64 v24, v[30:31] offset:128
    ds_write_b64 v24, v[32:33] offset:64
    ds_write_b64 v24, v[34:35] offset:192
km_xp_2:
km_l5:
    s_cmp_lg_u32 s50, 3
    s_cbranch_scc1 km_ld
    s_mov_b32 s50, 4
    s_branch km_l2
km_ld:
    s_min_u32 s12, s50, 3
    s_lshl_b32 s12, s12, 2
    v_add_u32 v22, s12, v22
    s_waitcnt vmcnt(0)
    s_mov_b64 exec, 1
    ds_add_u32 v22, v23 offset:0
    s_mov_b64 exec, -1
    v_mov_b32 v23, 77824
km_aww:
    ds_read_b32 v24, v23 offset:20
    s_waitcnt lgkmcnt(0)
    v_readfirstlane_b32 s12, v24
    s_cmp_eq_u32 s12, 16
    s_cbranch_scc1 km_aww_d
    s_sleep 1
    s_branch km_aww
km_aww_d:
    ds_read_b32 v25, v23 offset:32
km_awb:
    ds_read_b32 v24, v22 offset:0
    s_waitcnt lgkmcnt(0)
    v_readfirstlane_b32 s12, v24
    s_cmp_eq_u32 s12, 4
    s_cbranch_scc1 km_awb_d
    s_sleep 1
    s_branch km_awb
km_awb_d:
    v_readfirstlane_b32 s40, v25
    s_and_b32 s12, s29, 31
    s_lshl_b32 s12, s12, 4
    s_or_b32 s12, s12, s10
    s_cmp_lg_u32 s12, 15
    s_cbranch_scc1 km_nwb
    v_mov_b32 v24, 268288
    v_mov_b32 v25, s90
    global_store_dword v24, v25, s[4:5] sc1
    buffer_wbl2 sc1
km_nwb:
    v_add_u32 v1, 40960, v1
km_tile:
    s_setprio 1
    ds_read_b64 v[12:13], v4 offset:0
    ds_read_b64 v[14:15], v4 offset:512
    ds_read_b64 v[16:17], v4 offset:1024
    ds_read_b64 v[18:19], v4 offset:1536
    ds_read_b64 v[20:21], v4 offset:2048
    ds_read_b64 v[22:23], v4 offset:2560
    ds_read_b64 v[24:25], v4 offset:3072
    ds_read_b64 v[26:27], v4 offset:3584
    ds_read_b128 v[96:99], v1 offset:0
    ds_read_b128 v[100:103], v1 offset:1024
    ds_read_b128 v[104:107], v1 offset:2048
    ds_read_b128 v[108:111], v1 offset:3072
    ds_read_b128 v[112:115], v1 offset:4096
    s_waitcnt lgkmcnt(11)
    v_mfma_f32_16x16x32_bf16 v[40:43], v[12:15], v[12:15], 0
    s_waitcnt lgkmcnt(9)
    v_mfma_f32_16x16x32_bf16 v[40:43], v[16:19], v[16:19], v[40:43]
    s_waitcnt lgkmcnt(7)
    v_mfma_f32_16x16x32_bf16 v[40:43], v[20:23], v[20:23], v[40:43]
    s_waitcnt lgkmcnt(5)
    v_mfma_f32_16x16x32_bf16 v[40:43], v[24:27], v[24:27], v[40:43]
    s_waitcnt lgkmcnt(4)
    v_mfma_f32_16x16x32_bf16 v[120:123], v[96:99], v[12:15], 0
    ds_read_b128 v[116:119], v1 offset:5120
    s_waitcnt lgkmcnt(4)
    v_mfma_f32_16x16x32_bf16 v[120:123], v[100:103], v[16:19], v[120:123]
    ds_read_b128 v[96:99], v1 offset:6144
    s_waitcnt lgkmcnt(4)
    v_mfma_f32_16x16x32_bf16 v[120:123], v[104:107], v[20:23], v[120:123]
    ds_read_b128 v[100:103], v1 offset:7168
    s_waitcnt lgkmcnt(4)
    v_mfma_f32_16x16x32_bf16 v[120:123], v[108:111], v[24:27], v[120:123]
    ds_read_b128 v[104:107], v1 offset:8192
    s_waitcnt lgkmcnt(4)
    v_mfma_f32_16x16x32_bf16 v[80:83], v[112:115], v[12:15], 0
    ds_read_b128 v[108:111], v1 offset:9216
    s_waitcnt lgkmcnt(4)
    v_mfma_f32_16x16x32_bf16 v[80:83], v[116:119], v[16:19], v[80:83]
    ds_read_b128 v[112:115], v1 offset:10240
    s_waitcnt lgkmcnt(4)
    v_mfma_f32_16x16x32_bf16 v[80:83], v[96:99], v[20:23], v[80:83]
    ds_read_b128 v[116:119], v1 offset:11264
    s_waitcnt lgkmcnt(4)
    v_mfma_f32_16x16x32_bf16 v[80:83], v[100:103], v[24:27], v[80:83]
    ds_read_b128 v[96:99], v1 offset:12288
    s_waitcnt lgkmcnt(4)
    v_mfma_f32_16x16x32_bf16 v[84:87], v[104:107], v[12:15], 0
    ds_read_b128 v[100:103], v1 offset:13312
    s_waitcnt lgkmcnt(4)
    v_mfma_f32_16x16x32_bf16 v[84:87], v[108:111], v[16:19], v[84:87]
    ds_read_b128 v[104:107], v1 offset:14336
    s_waitcnt lgkmcnt(4)
    v_mfma_f32_16x16x32_bf16 v[84:87], v[112:115], v[20:23], v[84:87]
    ds_read_b128 v[108:111], v1 offset:15360
    s_waitcnt lgkmcnt(4)
    v_mfma_f32_16x16x32_bf16 v[84:87], v[116:119], v[24:27], v[84:87]
    ds_read_b128 v[112:115], v1 offset:16384
    s_waitcnt lgkmcnt(4)
    v_mfma_f32_16x16x32_bf16 v[88:91], v[96:99], v[12:15], 0
    ds_read_b128 v[116:119], v1 offset:17408
    v_cndmask_b32 v9, v40, v41, s[34:35]
    v_cndmask_b32 v10, v42, v43, s[34:35]
    s_waitcnt lgkmcnt(4)
    v_mfma_f32_16x16x32_bf16 v[88:91], v[100:103], v[16:19], v[88:91]
    ds_read_b128 v[96:99], v1 offset:18432
    v_cndmask_b32 v9, v9, v10, s[36:37]
    v_fma_f32 v10, v121, v121, -s33
    s_waitcnt lgkmcnt(4)
    v_mfma_f32_16x16x32_bf16 v[88:91], v[104:107], v[20:23], v[88:91]
    ds_read_b128 v[100:103], v1 offset:19456
    v_fma_f32 v9, v9, s41, -v10
    v_max_f32 v9, s33, v9
    s_waitcnt lgkmcnt(4)
    v_mfma_f32_16x16x32_bf16 v[88:91], v[108:111], v[24:27], v[88:91]
    ds_read_b128 v[104:107], v1 offset:20480
    v_rsq_f32 v9, v9
    ds_write2_b32 v5, v122, v123 offset0:16 offset1:32
    s_waitcnt lgkmcnt(5)
    v_mfma_f32_16x16x32_bf16 v[92:95], v[112:115], v[12:15], 0
    ds_read_b128 v[108:111], v1 offset:21504
    v_cvt_pk_bf16_f32 v72, v80, v81
    v_cvt_pk_bf16_f32 v73, v82, v83
    s_waitcnt lgkmcnt(5)
    v_mfma_f32_16x16x32_bf16 v[92:95], v[116:119], v[16:19], v[92:95]
    ds_read_b128 v[112:115], v1 offset:22528
    v_cvt_pk_bf16_f32 v74, v84, v85
    v_cvt_pk_bf16_f32 v75, v86, v87
    s_waitcnt lgkmcnt(5)
    v_mfma_f32_16x16x32_bf16 v[92:95], v[96:99], v[20:23], v[92:95]
    ds_read_b128 v[116:119], v1 offset:23552
    s_mov_b64 exec, s[38:39]
    ds_write_b32 v5, v9
    s_mov_b64 exec, -1
    ds_read_b32 v8, v5
    s_waitcnt lgkmcnt(7)
    v_mfma_f32_16x16x32_bf16 v[92:95], v[100:103], v[24:27], v[92:95]
    ds_read_b128 v[96:99], v1 offset:24576
    ds_read_b128 v[28:31], v6
    ds_read_b128 v[32:35], v6 offset:64
    v_mfma_f32_16x16x32_bf16 v[124:127], v[12:15], v[72:75], 0
    s_waitcnt lgkmcnt(9)
    v_mfma_f32_16x16x32_bf16 v[80:83], v[104:107], v[12:15], 0
    ds_read_b128 v[100:103], v1 offset:25600
    ds_read_b128 v[36:39], v6 offset:128
    s_waitcnt lgkmcnt(9)
    v_mfma_f32_16x16x32_bf16 v[80:83], v[108:111], v[16:19], v[80:83]
    ds_read_b128 v[104:107], v1 offset:26624
    s_waitcnt lgkmcnt(9)
    v_mfma_f32_16x16x32_bf16 v[80:83], v[112:115], v[20:23], v[80:83]
    ds_read_b128 v[108:111], v1 offset:27648
    s_waitcnt lgkmcnt(9)
    v_mfma_f32_16x16x32_bf16 v[80:83], v[116:119], v[24:27], v[80:83]
    ds_read_b128 v[112:115], v1 offset:28672
    s_waitcnt lgkmcnt(7)
    v_mfma_f32_16x16x32_bf16 v[84:87], v[96:99], v[12:15], 0
    ds_read_b128 v[116:119], v1 offset:29696
    v_cvt_pk_bf16_f32 v76, v88, v89
    v_cvt_pk_bf16_f32 v77, v90, v91
    s_waitcnt lgkmcnt(5)
    v_mfma_f32_16x16x32_bf16 v[84:87], v[100:103], v[16:19], v[84:87]
    ds_read_b128 v[96:99], v1 offset:30720
    v_cvt_pk_bf16_f32 v78, v92, v93
    v_cvt_pk_bf16_f32 v79, v94, v95
    s_waitcnt lgkmcnt(4)
    v_mfma_f32_16x16x32_bf16 v[84:87], v[104:107], v[20:23], v[84:87]
    ds_read_b128 v[100:103], v1 offset:31744
    s_waitcnt lgkmcnt(4)
    v_mfma_f32_16x16x32_bf16 v[84:87], v[108:111], v[24:27], v[84:87]
    ds_read_b128 v[104:107], v1 offset:32768
    v_mfma_f32_16x16x32_bf16 v[124:127], v[16:19], v[76:79], v[124:127]
    s_waitcnt lgkmcnt(4)
    v_mfma_f32_16x16x32_bf16 v[88:91], v[112:115], v[12:15], 0
    ds_read_b128 v[108:111], v1 offset:33792
    s_waitcnt lgkmcnt(4)
    v_mfma_f32_16x16x32_bf16 v[88:91], v[116:119], v[16:19], v[88:91]
    ds_read_b128 v[112:115], v1 offset:34816
    s_waitcnt lgkmcnt(4)
    v_mfma_f32_16x16x32_bf16 v[88:91], v[96:99], v[20:23], v[88:91]
    ds_read_b128 v[116:119], v1 offset:35840
    s_waitcnt lgkmcnt(4)
    v_mfma_f32_16x16x32_bf16 v[88:91], v[100:103], v[24:27], v[88:91]
    v_add_u32 v1, 81920, v1
    ds_read_b128 v[96:99], v1 offset:0
    s_waitcnt lgkmcnt(4)
    v_mfma_f32_16x16x32_bf16 v[92:95], v[104:107], v[12:15], 0
    ds_read_b128 v[100:103], v1 offset:1024
    v_cvt_pk_bf16_f32 v72, v80, v81
    v_cvt_pk_bf16_f32 v73, v82, v83
    s_waitcnt lgkmcnt(4)
    v_mfma_f32_16x16x32_bf16 v[92:95], v[108:111], v[16:19], v[92:95]
    ds_read_b128 v[104:107], v1 offset:2048
    v_cvt_pk_bf16_f32 v74, v84, v85
    v_cvt_pk_bf16_f32 v75, v86, v87
    s_waitcnt lgkmcnt(4)
    v_mfma_f32_16x16x32_bf16 v[92:95], v[112:115], v[20:23], v[92:95]
    ds_read_b128 v[108:111], v1 offset:3072
    s_waitcnt lgkmcnt(4)
    v_mfma_f32_16x16x32_bf16 v[92:95], v[116:119], v[24:27], v[92:95]
    ds_read_b128 v[112:115], v1 offset:4096
    v_mfma_f32_16x16x32_bf16 v[124:127], v[20:23], v[72:75], v[124:127]
    s_waitcnt lgkmcnt(4)
    v_mfma_f32_16x16x32_bf16 v[80:83], v[12:15], v[96:99], 0
    ds_read_b128 v[116:119], v1 offset:5120
    s_waitcnt lgkmcnt(4)
    v_mfma_f32_16x16x32_bf16 v[80:83], v[16:19], v[100:103], v[80:83]
    ds_read_b128 v[96:99], v1 offset:6144
    s_waitcnt lgkmcnt(4)
    v_mfma_f32_16x16x32_bf16 v[80:83], v[20:23], v[104:107], v[80:83]
    ds_read_b128 v[100:103], v1 offset:7168
    s_waitcnt lgkmcnt(4)
    v_mfma_f32_16x16x32_bf16 v[80:83], v[24:27], v[108:111], v[80:83]
    ds_read_b128 v[104:107], v1 offset:8192
    s_waitcnt lgkmcnt(4)
    v_mfma_f32_16x16x32_bf16 v[84:87], v[12:15], v[112:115], 0
    ds_read_b128 v[108:111], v1 offset:9216
    v_cvt_pk_bf16_f32 v76, v88, v89
    v_cvt_pk_bf16_f32 v77, v90, v91
    s_waitcnt lgkmcnt(4)
    v_mfma_f32_16x16x32_bf16 v[84:87], v[16:19], v[116:119], v[84:87]
    ds_read_b128 v[112:115], v1 offset:10240
    v_cvt_pk_bf16_f32 v78, v92, v93
    v_cvt_pk_bf16_f32 v79, v94, v95
    s_waitcnt lgkmcnt(4)
    v_mfma_f32_16x16x32_bf16 v[84:87], v[20:23], v[96:99], v[84:87]
    ds_read_b128 v[116:119], v1 offset:11264
    s_waitcnt lgkmcnt(4)
    v_mfma_f32_16x16x32_bf16 v[84:87], v[24:27], v[100:103], v[84:87]
    ds_read_b128 v[96:99], v1 offset:12288
    v_mfma_f32_16x16x32_bf16 v[124:127], v[24:27], v[76:79], v[124:127]
    s_waitcnt lgkmcnt(4)
    v_mfma_f32_16x16x32_bf16 v[88:91], v[12:15], v[104:107], 0
    ds_read_b128 v[100:103], v1 offset:13312
    v_cvt_pk_bf16_f32 v60, v80, v81
    v_cvt_pk_bf16_f32 v61, v82, v83
    s_waitcnt lgkmcnt(4)
    v_mfma_f32_16x16x32_bf16 v[88:91], v[16:19], v[108:111], v[88:91]
    ds_read_b128 v[104:107], v1 offset:14336
    v_cvt_pk_bf16_f32 v64, v84, v85
    v_cvt_pk_bf16_f32 v65, v86, v87
    s_waitcnt lgkmcnt(4)
    v_mfma_f32_16x16x32_bf16 v[88:91], v[20:23], v[112:115], v[88:91]
    ds_read_b128 v[108:111], v1 offset:15360
    v_mov_b64 v[70:71], v[12:13]
    v_mov_b64 v[66:67], v[14:15]
    s_waitcnt lgkmcnt(4)
    v_mfma_f32_16x16x32_bf16 v[88:91], v[24:27], v[116:119], v[88:91]
    ds_read_b128 v[112:115], v1 offset:16384
    v_mul_f32 v124, v124, v28
    v_mul_f32 v125, v125, v29
    s_waitcnt lgkmcnt(4)
    v_mfma_f32_16x16x32_bf16 v[92:95], v[12:15], v[96:99], 0
    ds_read_b128 v[116:119], v1 offset:17408
    v_mul_f32 v126, v126, v30
    v_mul_f32 v127, v127, v31
    s_waitcnt lgkmcnt(4)
    v_mfma_f32_16x16x32_bf16 v[92:95], v[16:19], v[100:103], v[92:95]
    ds_read_b128 v[96:99], v1 offset:18432
    v_max_f32 v9, v124, v125
    v_max3_f32 v9, v9, v126, v127
    s_waitcnt lgkmcnt(4)
    v_mfma_f32_16x16x32_bf16 v[92:95], v[20:23], v[104:107], v[92:95]
    ds_read_b128 v[100:103], v1 offset:19456
    v_mov_b32 v10, v9
    s_nop 1
    v_permlane16_swap_b32 v9, v10
    s_waitcnt lgkmcnt(4)
    v_mfma_f32_16x16x32_bf16 v[92:95], v[24:27], v[108:111], v[92:95]
    ds_read_b128 v[104:107], v1 offset:20480
    v_max_f32 v9, v9, v10
    v_mul_f32 v9, v9, v8
    v_fma_f32 v124, v124, v8, -v9
    v_fma_f32 v125, v125, v8, -v9
    v_fma_f32 v126, v126, v8, -v9
    v_fma_f32 v127, v127, v8, -v9
    v_exp_f32 v124, v124
    v_exp_f32 v125, v125
    v_exp_f32 v126, v126
    v_exp_f32 v127, v127
    v_add_f32 v9, v124, v125
    v_add_f32 v10, v126, v127
    v_add_f32 v9, v9, v10
    v_mov_b32 v10, v9
    s_nop 1
    v_permlane16_swap_b32 v9, v10
    v_add_f32 v9, v9, v10
    v_rcp_f32 v9, v9
    v_mul_f32 v124, v124, v28
    v_mul_f32 v125, v125, v29
    v_mul_f32 v126, v126, v30
    v_mul_f32 v127, v127, v31
    v_and_b32 v9, v11, v9
    v_mul_f32 v124, v124, v9
    v_mul_f32 v125, v125, v9
    v_mul_f32 v126, v126, v9
    v_mul_f32 v127, v127, v9
    v_cvt_pk_bf16_f32 v68, v124, v125
    v_cvt_pk_bf16_f32 v69, v126, v127
    v_mul_f32 v122, v124, v32
    v_mul_f32 v123, v124, v36
    v_fmac_f32 v122, v125, v33
    v_fmac_f32 v123, v125, v37
    v_fmac_f32 v122, v126, v34
    v_fmac_f32 v123, v126, v38
    v_fmac_f32 v122, v127, v35
    v_fmac_f32 v123, v127, v39
    v_mfma_f32_16x16x32_bf16 v[28:31], v[68:71], v[60:63], 0
    v_mfma_f32_16x16x32_bf16 v[32:35], v[66:69], v[62:65], 0
    s_waitcnt lgkmcnt(4)
    v_mfma_f32_16x16x32_bf16 v[80:83], v[12:15], v[112:115], 0
    ds_read_b128 v[108:111], v1 offset:21504
    v_mov_b64 v[70:71], v[16:17]
    v_mov_b64 v[66:67], v[18:19]
    s_waitcnt lgkmcnt(4)
    v_mfma_f32_16x16x32_bf16 v[80:83], v[16:19], v[116:119], v[80:83]
    ds_read_b128 v[112:115], v1 offset:22528
    v_cvt_pk_bf16_f32 v60, v88, v89
    v_cvt_pk_bf16_f32 v61, v90, v91
    s_waitcnt lgkmcnt(4)
    v_mfma_f32_16x16x32_bf16 v[80:83], v[20:23], v[96:99], v[80:83]
    ds_read_b128 v[116:119], v1 offset:23552
    v_cvt_pk_bf16_f32 v64, v92, v93
    v_cvt_pk_bf16_f32 v65, v94, v95
    s_waitcnt lgkmcnt(4)
    v_mfma_f32_16x16x32_bf16 v[80:83], v[24:27], v[100:103], v[80:83]
    ds_read_b128 v[96:99], v1 offset:24576
    v_permlane16_swap_b32 v122, v123
    v_add_f32 v120, v120, v122
    s_waitcnt lgkmcnt(4)
    v_mfma_f32_16x16x32_bf16 v[84:87], v[12:15], v[104:107], 0
    ds_read_b128 v[100:103], v1 offset:25600
    v_add_f32 v120, v120, v123
    s_mov_b64 exec, s[42:43]
    ds_write_b32 v0, v120 offset:192
    s_mov_b64 exec, -1
    s_waitcnt lgkmcnt(5)
    v_mfma_f32_16x16x32_bf16 v[84:87], v[16:19], v[108:111], v[84:87]
    ds_read_b128 v[104:107], v1 offset:26624
    ds_read2_b32 v[120:121], v7 offset0:48 offset1:64
    s_waitcnt lgkmcnt(6)
    v_mfma_f32_16x16x32_bf16 v[84:87], v[20:23], v[112:115], v[84:87]
    ds_read_b128 v[108:111], v1 offset:27648
    s_waitcnt lgkmcnt(6)
    v_mfma_f32_16x16x32_bf16 v[84:87], v[24:27], v[116:119], v[84:87]
    ds_read_b128 v[112:115], v1 offset:28672
    v_mfma_f32_16x16x32_bf16 v[36:39], v[68:71], v[60:63], 0
    v_mfma_f32_16x16x32_bf16 v[40:43], v[66:69], v[62:65], 0
    s_waitcnt lgkmcnt(6)
    v_mfma_f32_16x16x32_bf16 v[88:91], v[12:15], v[96:99], 0
    ds_read_b128 v[116:119], v1 offset:29696
    v_mov_b64 v[70:71], v[20:21]
    v_mov_b64 v[66:67], v[22:23]
    s_waitcnt lgkmcnt(6)
    v_mfma_f32_16x16x32_bf16 v[88:91], v[16:19], v[100:103], v[88:91]
    ds_read_b128 v[96:99], v1 offset:30720
    v_cvt_pk_bf16_f32 v60, v80, v81
    v_cvt_pk_bf16_f32 v61, v82, v83
    s_waitcnt lgkmcnt(5)
    v_mfma_f32_16x16x32_bf16 v[88:91], v[20:23], v[104:107], v[88:91]
    ds_read_b128 v[100:103], v1 offset:31744
    v_cvt_pk_bf16_f32 v64, v84, v85
    v_cvt_pk_bf16_f32 v65, v86, v87
    s_waitcnt lgkmcnt(4)
    v_mfma_f32_16x16x32_bf16 v[88:91], v[24:27], v[108:111], v[88:91]
    v_mul_f32 v124, v28, v28
    v_mul_f32 v125, v29, v29
    s_waitcnt lgkmcnt(3)
    v_mfma_f32_16x16x32_bf16 v[92:95], v[12:15], v[112:115], 0
    v_mul_f32 v126, v30, v30
    v_mul_f32 v127, v31, v31
    s_waitcnt lgkmcnt(2)
    v_mfma_f32_16x16x32_bf16 v[92:95], v[16:19], v[116:119], v[92:95]
    v_fmac_f32 v124, v32, v32
    v_fmac_f32 v125, v33, v33
    s_waitcnt lgkmcnt(1)
    v_mfma_f32_16x16x32_bf16 v[92:95], v[20:23], v[96:99], v[92:95]
    v_fmac_f32 v126, v34, v34
    v_fmac_f32 v127, v35, v35
    s_waitcnt lgkmcnt(0)
    v_mfma_f32_16x16x32_bf16 v[92:95], v[24:27], v[100:103], v[92:95]
    v_fma_f32 v121, -v120, s40, v121
    v_fma_f32 v120, v120, v120, -s33
    v_mul_f32 v121, 0x3fb8aa3b, v121
    v_mfma_f32_16x16x32_bf16 v[44:47], v[68:71], v[60:63], 0
    v_mfma_f32_16x16x32_bf16 v[48:51], v[66:69], v[62:65], 0
    v_mov_b64 v[70:71], v[24:25]
    v_mov_b64 v[66:67], v[26:27]
    v_fmac_f32 v124, v36, v36
    v_fmac_f32 v125, v37, v37
    v_fmac_f32 v126, v38, v38
    v_fmac_f32 v127, v39, v39
    v_fmac_f32 v124, v40, v40
    v_fmac_f32 v125, v41, v41
    v_fmac_f32 v126, v42, v42
    v_fmac_f32 v127, v43, v43
    v_cvt_pk_bf16_f32 v60, v88, v89
    v_cvt_pk_bf16_f32 v61, v90, v91
    v_cvt_pk_bf16_f32 v64, v92, v93
    v_cvt_pk_bf16_f32 v65, v94, v95
    v_mfma_f32_16x16x32_bf16 v[52:55], v[68:71], v[60:63], 0
    s_nop 0
    v_mfma_f32_16x16x32_bf16 v[56:59], v[66:69], v[62:65], 0
    s_setprio 0
    v_fmac_f32 v124, v44, v44
    v_fmac_f32 v125, v45, v45
    v_fmac_f32 v126, v46, v46
    v_fmac_f32 v127, v47, v47
    v_fmac_f32 v124, v48, v48
    v_fmac_f32 v125, v49, v49
    v_fmac_f32 v126, v50, v50
    v_fmac_f32 v127, v51, v51
    v_fmac_f32 v124, v52, v52
    v_fmac_f32 v125, v53, v53
    v_fmac_f32 v126, v54, v54
    v_fmac_f32 v127, v55, v55
    v_fmac_f32 v124, v56, v56
    v_fmac_f32 v125, v57, v57
    v_fmac_f32 v126, v58, v58
    v_fmac_f32 v127, v59, v59
    v_add_f32_dpp v124, v124, v124 row_ror:8 row_mask:0xf bank_mask:0x3
    v_add_f32_dpp v125, v125, v125 row_ror:8 row_mask:0xf bank_mask:0x3
    s_nop 0
    v_add_f32_dpp v124, v126, v126 row_ror:8 row_mask:0xf bank_mask:0xc
    v_add_f32_dpp v125, v127, v127 row_ror:8 row_mask:0xf bank_mask:0xc
    s_nop 0
    v_add_f32_dpp v9, v124, v124 row_shl:4 row_mask:0xf bank_mask:0x5
    s_nop 1
    v_add_f32_dpp v9, v125, v125 row_shr:4 row_mask:0xf bank_mask:0xa
    s_nop 1
    v_add_f32_dpp v9, v9, v9 quad_perm:[1,0,3,2] row_mask:0xf bank_mask:0xf
    s_nop 1
    v_add_f32_dpp v9, v9, v9 quad_perm:[2,3,0,1] row_mask:0xf bank_mask:0xf
    v_fma_f32 v9, v9, s41, -v120
    v_max_f32 v9, s33, v9
    v_rsq_f32 v9, v9
    s_nop 0
    v_mul_f32 v121, v121, v9
    s_nop 1
    v_max_f32_dpp v9, v121, v121 row_ror:8 row_mask:0xf bank_mask:0xf
    s_nop 1
    v_max_f32_dpp v9, v9, v9 row_ror:4 row_mask:0xf bank_mask:0xf
    v_mov_b32 v10, v9
    s_nop 1
    v_permlane16_swap_b32 v9, v10
    v_max_f32 v9, v9, v10
    v_sub_f32 v121, v121, v9
    v_exp_f32 v121, v121
    s_nop 1
    v_add_f32_dpp v9, v121, v121 row_ror:8 row_mask:0xf bank_mask:0xf
    s_nop 1
    v_add_f32_dpp v9, v9, v9 row_ror:4 row_mask:0xf bank_mask:0xf
    v_mov_b32 v10, v9
    s_nop 1
    v_permlane16_swap_b32 v9, v10
    v_add_f32 v9, v9, v10
    v_rcp_f32 v9, v9
    s_nop 0
    v_mul_f32 v121, v121, v9
    s_nop 1
    v_mul_f32_dpp v28, v121, v28 row_newbcast:0 row_mask:0xf bank_mask:0xf
    v_mul_f32_dpp v32, v121, v32 row_newbcast:0 row_mask:0xf bank_mask:0xf
    v_mul_f32_dpp v36, v121, v36 row_newbcast:0 row_mask:0xf bank_mask:0xf
    v_mul_f32_dpp v40, v121, v40 row_newbcast:0 row_mask:0xf bank_mask:0xf
    v_mul_f32_dpp v44, v121, v44 row_newbcast:0 row_mask:0xf bank_mask:0xf
    v_mul_f32_dpp v48, v121, v48 row_newbcast:0 row_mask:0xf bank_mask:0xf
    v_mul_f32_dpp v52, v121, v52 row_newbcast:0 row_mask:0xf bank_mask:0xf
    v_mul_f32_dpp v56, v121, v56 row_newbcast:0 row_mask:0xf bank_mask:0xf
    v_fmac_f32_dpp v28, v121, v29 row_newbcast:4 row_mask:0xf bank_mask:0xf
    v_fmac_f32_dpp v32, v121, v33 row_newbcast:4 row_mask:0xf bank_mask:0xf
    v_fmac_f32_dpp v36, v121, v37 row_newbcast:4 row_mask:0xf bank_mask:0xf
    v_fmac_f32_dpp v40, v121, v41 row_newbcast:4 row_mask:0xf bank_mask:0xf
    v_fmac_f32_dpp v44, v121, v45 row_newbcast:4 row_mask:0xf bank_mask:0xf
    v_fmac_f32_dpp v48, v121, v49 row_newbcast:4 row_mask:0xf bank_mask:0xf
    v_fmac_f32_dpp v52, v121, v53 row_newbcast:4 row_mask:0xf bank_mask:0xf
    v_fmac_f32_dpp v56, v121, v57 row_newbcast:4 row_mask:0xf bank_mask:0xf
    v_fmac_f32_dpp v28, v121, v30 row_newbcast:8 row_mask:0xf bank_mask:0xf
    v_fmac_f32_dpp v32, v121, v34 row_newbcast:8 row_mask:0xf bank_mask:0xf
    v_fmac_f32_dpp v36, v121, v38 row_newbcast:8 row_mask:0xf bank_mask:0xf
    v_fmac_f32_dpp v40, v121, v42 row_newbcast:8 row_mask:0xf bank_mask:0xf
    v_fmac_f32_dpp v44, v121, v46 row_newbcast:8 row_mask:0xf bank_mask:0xf
    v_fmac_f32_dpp v48, v121, v50 row_newbcast:8 row_mask:0xf bank_mask:0xf
    v_fmac_f32_dpp v52, v121, v54 row_newbcast:8 row_mask:0xf bank_mask:0xf
    v_fmac_f32_dpp v56, v121, v58 row_newbcast:8 row_mask:0xf bank_mask:0xf
    v_fmac_f32_dpp v28, v121, v31 row_newbcast:12 row_mask:0xf bank_mask:0xf
    v_fmac_f32_dpp v32, v121, v35 row_newbcast:12 row_mask:0xf bank_mask:0xf
    v_fmac_f32_dpp v36, v121, v39 row_newbcast:12 row_mask:0xf bank_mask:0xf
    v_fmac_f32_dpp v40, v121, v43 row_newbcast:12 row_mask:0xf bank_mask:0xf
    v_fmac_f32_dpp v44, v121, v47 row_newbcast:12 row_mask:0xf bank_mask:0xf
    v_fmac_f32_dpp v48, v121, v51 row_newbcast:12 row_mask:0xf bank_mask:0xf
    v_fmac_f32_dpp v52, v121, v55 row_newbcast:12 row_mask:0xf bank_mask:0xf
    v_fmac_f32_dpp v56, v121, v59 row_newbcast:12 row_mask:0xf bank_mask:0xf
    v_permlane16_swap_b32 v28, v44
    v_permlane16_swap_b32 v32, v48
    v_permlane16_swap_b32 v36, v52
    v_permlane16_swap_b32 v40, v56
    v_add_f32 v28, v28, v44
    v_add_f32 v32, v32, v48
    v_add_f32 v36, v36, v52
    v_add_f32 v40, v40, v56
    v_cvt_pk_bf16_f32 v28, v28, v32
    v_cvt_pk_bf16_f32 v36, v36, v40
    ds_write_b16 v2, v28
    ds_write_b16_d16_hi v2, v28 offset:32
    ds_write_b16 v2, v36 offset:64
    ds_write_b16_d16_hi v2, v36 offset:96
    v_and_b32 v10, 0x1f0, v1
    v_add_u32 v9, s44, v10
    ds_read_b128 v[44:47], v9
    s_mov_b32 exec_hi, 0
    s_waitcnt lgkmcnt(0)
    global_store_dwordx4 v10, v[44:47], s[30:31] sc1
    s_mov_b32 exec_hi, -1
    s_cmp_ge_u32 s32, 4
    s_cbranch_scc1 km_fin
    s_mov_b32 s32, 4
    v_add_u32 v4, 16384, v4
    v_subrev_u32 v1, 81920, v1
    s_add_u32 s30, s30, 8192
    s_addc_u32 s31, s31, 0
    v_mov_b32 v22, 77824
km_aw4:
    ds_read_b32 v24, v22 offset:12
    s_waitcnt lgkmcnt(0)
    v_readfirstlane_b32 s12, v24
    s_cmp_eq_u32 s12, 4
    s_cbranch_scc1 km_aw4_d
    s_sleep 1
    s_branch km_aw4
km_aw4_d:
    s_branch km_tile
km_fin:
km_end:
    s_endpgm
kms_next:
    v_add_lshl_u32 v29, v1, s40, 2
    ds_read_b32 v4, v29 offset:52224
    s_waitcnt lgkmcnt(0)
    s_branch kms_have
    kms_ovf:
    s_andn2_b64 s[36:37], s[36:37], exec
    v_mov_b32 v16, 42248
    ds_add_rtn_u32 v16, v16, v34
    s_mul_i32 s15, s6, 1280000
    s_add_u32 s15, s15, 50331648
    s_add_u32 s38, s4, s15
    s_addc_u32 s39, s5, 0
    s_waitcnt lgkmcnt(0)
    v_lshlrev_b32 v16, 2, v16
    global_store_dword v16, v4, s[38:39] sc1
    s_waitcnt vmcnt(0)
    s_branch kms_placed
    kms_more:
    s_waitcnt lgkmcnt(0)
    s_barrier
    v_mov_b32 v29, 42256
    v_mov_b32 v30, 0
    ds_write_b32 v29, v30
    ds_write_b32 v29, v30 offset:4
    v_add_u32 v32, 240, v32
    v_subrev_u32 v31, 60, v31
    v_cmp_lt_i32 s[20:21], 0, v31
    v_cmp_lt_i32 s[22:23], 12, v31
    v_cmp_lt_i32 s[24:25], 24, v31
    v_cmp_lt_i32 s[26:27], 36, v31
    v_cmp_lt_i32 s[28:29], 48, v31
    v_cmp_lt_i32 vcc, 60, v31
    global_load_dword v4, v32, s[12:13] offset:0 sc1
    global_load_dword v5, v32, s[12:13] offset:48 sc1
    s_or_b64 exec, s[24:25], 1
    global_load_dword v6, v32, s[12:13] offset:96 sc1
    s_or_b64 exec, s[26:27], 1
    global_load_dword v7, v32, s[12:13] offset:144 sc1
    s_or_b64 exec, s[28:29], 1
    global_load_dword v8, v32, s[12:13] offset:192 sc1
    s_mov_b64 exec, -1
    s_waitcnt vmcnt(0) lgkmcnt(0)
    s_barrier
    s_mov_b64 exec, vcc
    v_mov_b32 v29, 42260
    ds_write_b32 v29, v34
    s_mov_b64 exec, -1
    s_branch kms_append
kms_other:
kms_fin:
    s_cmp_lg_u32 s14, 15
    s_cbranch_scc1 km_rpb
    s_mov_b64 s[82:83], vcc
    s_waitcnt vmcnt(0)
km_rqb:
    v_subrev_u32 v114, s90, v112
    v_cmp_lt_u32 vcc, 1, v114
    s_cbranch_vccnz km_rwb
    v_cmp_ne_u32 vcc, 0, v114
    s_and_b32 s78, vcc_lo, 0xff
    s_lshl_b32 s78, s78, 9
    s_or_b32 s78, s78, s76
    v_mov_b32 v112, 77816
    v_mov_b32 v114, s78
    ds_write_b32 v112, v114
    s_mov_b64 vcc, s[82:83]
km_rpb:
    s_waitcnt vmcnt(0) lgkmcnt(0)
    s_barrier
    v_mov_b32 v112, 77816
    ds_read_b32 v112, v112
    s_waitcnt lgkmcnt(0)
    v_readfirstlane_b32 s78, v112
    s_and_b32 s76, s78, 255
    s_lshr_b32 s85, s78, 9
kms_late:
    s_cmp_ge_u32 s14, 13
    s_cbranch_scc1 km_p0b
km_p0rb:
    s_branch kms_join
kms_weights:
    s_sub_u32 s15, s2, 160
    s_lshl_b32 s15, s15, 4
    s_add_u32 s15, s15, 32
    s_load_dwordx4 s[8:11], s[0:1], s15
    s_load_dwordx2 s[12:13], s[0:1], 64
    s_lshr_b32 s17, s14, 2
    s_and_b32 s18, s14, 3
    v_lshrrev_b32 v2, 4, v1
    s_and_b32 s16, s14, 1
    s_lshl_b32 s16, s16, 1
    v_lshl_or_b32 v3, v2, 2, s16
    s_lshl_b32 s15, s14, 3
    v_add_u32 v2, s15, v2
    v_xor_b32 v3, v3, v1
    v_and_b32 v3, 15, v3
    v_lshlrev_b32 v3, 4, v3
    v_lshl_add_u32 v2, v2, 8, v3
    v_xor_b32 v3, 16, v2
    s_lshl_b32 s15, s14, 11
    s_add_u32 m0, s15, 40960
    s_waitcnt lgkmcnt(0)
    global_load_lds_dwordx4 v2, s[8:9]
    global_load_lds_dwordx4 v3, s[8:9] offset:1024
    s_add_u32 m0, s15, 122880
    v_lshrrev_b32 v101, 5, v1
    global_load_lds_dwordx4 v2, s[10:11]
    global_load_lds_dwordx4 v3, s[10:11] offset:1024
    s_lshl_b32 s15, s18, 6
    v_lshl_add_u32 v102, v101, 3, s15
    global_load_dwordx2 v[68:69], v102, s[12:13]
    global_load_dwordx2 v[70:71], v102, s[12:13] offset:16
    global_load_dwordx2 v[72:73], v102, s[12:13] offset:32
    global_load_dwordx2 v[74:75], v102, s[12:13] offset:48
    v_and_b32 v2, 127, v0
    v_lshlrev_b32 v2, 2, v2
    v_add_u32 v2, 73728, v2
    v_mov_b32 v84, 0
    ds_write_b32 v2, v84
    v_and_b32 v100, 31, v1
    v_and_b32 v2, 3, v100
    v_bfe_u32 v3, v100, 2, 2
    v_lshl_or_b32 v2, v2, 2, v3
    v_xor_b32 v2, v2, v101
    v_lshlrev_b32 v2, 4, v2
    v_lshl_add_u32 v2, v100, 8, v2
    s_lshl_b32 s15, s17, 13
    s_add_u32 s15, s15, 40960
    v_add_u32 v3, s15, v2
    s_mul_i32 s90, s91, 0x9e3779b1
    s_add_u32 s90, s90, 0x7f4a7c15
    s_cmp_lg_u32 s14, 15
    s_cbranch_scc1 km_c2w
    s_waitcnt vmcnt(0)
    s_getpc_b64 s[82:83]
    s_branch km_pick
km_c2w:
    s_cmp_lg_u32 s14, 15
    s_cbranch_scc1 km_c3dw
    s_branch km_c3bw
km_c3aw:
    s_getpc_b64 s[82:83]
    s_branch km_relook
km_c3bw:
    s_waitcnt vmcnt(0)
    v_cmp_ne_u32 vcc, v116, v115
    s_cbranch_vccnz km_c3aw
    global_load_dword v112, v113, s[4:5] sc1
km_c3dw:
    s_cmp_lg_u32 s14, 15
    s_cbranch_scc1 km_rpw
    s_mov_b64 s[82:83], vcc
    s_waitcnt vmcnt(0)
km_rqw:
    v_subrev_u32 v114, s90, v112
    v_cmp_lt_u32 vcc, 1, v114
    s_cbranch_vccnz km_rww
    v_cmp_ne_u32 vcc, 0, v114
    s_and_b32 s78, vcc_lo, 0xff
    s_lshl_b32 s78, s78, 9
    s_or_b32 s78, s78, s76
    v_mov_b32 v112, 77816
    v_mov_b32 v114, s78
    ds_write_b32 v112, v114
    s_mov_b64 vcc, s[82:83]
km_rpw:
    s_waitcnt vmcnt(0) lgkmcnt(0)
    s_barrier
    v_mov_b32 v112, 77816
    ds_read_b32 v112, v112
    s_waitcnt lgkmcnt(0)
    v_readfirstlane_b32 s78, v112
    s_and_b32 s76, s78, 255
    s_lshr_b32 s85, s78, 9
    s_cmp_eq_u32 s2, 161
    s_cbranch_scc1 kms_wo
    s_lshl_b32 s15, s18, 13
    s_add_u32 s15, s15, 122880
    v_add_u32 v2, s15, v2
    v_xor_b32 v84, 0, v2
    ds_read_b128 v[36:39], v84
    v_xor_b32 v85, 32, v2
    ds_read_b128 v[40:43], v85
    v_xor_b32 v86, 64, v2
    ds_read_b128 v[44:47], v86
    v_xor_b32 v87, 96, v2
    ds_read_b128 v[48:51], v87
    v_xor_b32 v88, 128, v2
    ds_read_b128 v[52:55], v88
    v_xor_b32 v89, 160, v2
    ds_read_b128 v[56:59], v89
    v_xor_b32 v90, 192, v2
    ds_read_b128 v[60:63], v90
    v_xor_b32 v91, 224, v2
    ds_read_b128 v[64:67], v91
    s_branch kms_mm
kms_wo:
    v_bfe_u32 v2, v1, 2, 2
    v_lshl_add_u32 v2, v101, 3, v2
    v_bfe_u32 v84, v1, 4, 1
    v_bfe_u32 v85, v1, 1, 1
    v_lshl_add_u32 v84, v84, 1, v85
    s_lshl_b32 s15, s18, 2
    v_add_u32 v84, s15, v84
    v_and_b32 v85, 12, v1
    v_lshl_or_b32 v85, v101, 1, v85
    v_xor_b32 v84, v84, v85
    v_lshlrev_b32 v84, 4, v84
    v_lshl_add_u32 v2, v2, 8, v84
    v_and_b32 v84, 1, v1
    v_lshl_add_u32 v2, v84, 3, v2
    v_add_u32 v2, 122880, v2
    v_xor_b32 v84, 16, v2
    ds_read_b64_tr_b16 v[36:37], v2 offset:0
    ds_read_b64_tr_b16 v[38:39], v84 offset:1024
    ds_read_b64_tr_b16 v[40:41], v2 offset:4096
    ds_read_b64_tr_b16 v[42:43], v84 offset:5120
    ds_read_b64_tr_b16 v[44:45], v2 offset:8192
    ds_read_b64_tr_b16 v[46:47], v84 offset:9216
    ds_read_b64_tr_b16 v[48:49], v2 offset:12288
    ds_read_b64_tr_b16 v[50:51], v84 offset:13312
    ds_read_b64_tr_b16 v[52:53], v2 offset:16384
    ds_read_b64_tr_b16 v[54:55], v84 offset:17408
    ds_read_b64_tr_b16 v[56:57], v2 offset:20480
    ds_read_b64_tr_b16 v[58:59], v84 offset:21504
    ds_read_b64_tr_b16 v[60:61], v2 offset:24576
    ds_read_b64_tr_b16 v[62:63], v84 offset:25600
    ds_read_b64_tr_b16 v[64:65], v2 offset:28672
    ds_read_b64_tr_b16 v[66:67], v84 offset:29696
kms_mm:
    v_xor_b32 v92, 0, v3
    ds_read_b128 v[4:7], v92
    v_xor_b32 v93, 32, v3
    ds_read_b128 v[8:11], v93
    v_xor_b32 v94, 64, v3
    ds_read_b128 v[12:15], v94
    v_xor_b32 v95, 96, v3
    ds_read_b128 v[16:19], v95
    v_xor_b32 v96, 128, v3
    ds_read_b128 v[20:23], v96
    v_xor_b32 v97, 160, v3
    ds_read_b128 v[24:27], v97
    v_xor_b32 v98, 192, v3
    ds_read_b128 v[28:31], v98
    v_xor_b32 v99, 224, v3
    ds_read_b128 v[32:35], v99
    s_waitcnt lgkmcnt(0)
    v_mfma_f32_32x32x16_bf16 v[84:99], v[36:39], v[4:7], 0
    v_mfma_f32_32x32x16_bf16 v[84:99], v[40:43], v[8:11], v[84:99]
    v_mfma_f32_32x32x16_bf16 v[84:99], v[44:47], v[12:15], v[84:99]
    v_mfma_f32_32x32x16_bf16 v[84:99], v[48:51], v[16:19], v[84:99]
    v_mfma_f32_32x32x16_bf16 v[84:99], v[52:55], v[20:23], v[84:99]
    v_mfma_f32_32x32x16_bf16 v[84:99], v[56:59], v[24:27], v[84:99]
    v_mfma_f32_32x32x16_bf16 v[84:99], v[60:63], v[28:31], v[84:99]
    v_mfma_f32_32x32x16_bf16 v[84:99], v[64:67], v[32:35], v[84:99]
    s_cmp_eq_u32 s2, 161
    s_cbranch_scc1 kms_rw
    s_nop 7
    s_nop 1
    v_add_f32 v2, v84, v85
    v_add_f32 v2, v2, v86
    v_add_f32 v2, v2, v87
    v_add_f32 v2, v2, v88
    v_add_f32 v2, v2, v89
    v_add_f32 v2, v2, v90
    v_add_f32 v2, v2, v91
    v_add_f32 v2, v2, v92
    v_add_f32 v2, v2, v93
    v_add_f32 v2, v2, v94
    v_add_f32 v2, v2, v95
    v_add_f32 v2, v2, v96
    v_add_f32 v2, v2, v97
    v_add_f32 v2, v2, v98
    v_add_f32 v2, v2, v99
    s_branch kms_rdn
kms_rw:
    v_mov_b32 v2, 0
    v_mov_b32 v3, 0
    s_nop 7
    v_lshlrev_b32 v103, 16, v68
    v_add_f32 v2, v2, v84
    v_fmac_f32 v3, v103, v84
    v_mov_b32 v84, v103
    v_and_b32 v103, 0xffff0000, v68
    v_add_f32 v2, v2, v85
    v_fmac_f32 v3, v103, v85
    v_mov_b32 v85, v103
    v_lshlrev_b32 v103, 16, v69
    v_add_f32 v2, v2, v86
    v_fmac_f32 v3, v103, v86
    v_mov_b32 v86, v103
    v_and_b32 v103, 0xffff0000, v69
    v_add_f32 v2, v2, v87
    v_fmac_f32 v3, v103, v87
    v_mov_b32 v87, v103
    v_lshlrev_b32 v103, 16, v70
    v_add_f32 v2, v2, v88
    v_fmac_f32 v3, v103, v88
    v_mov_b32 v88, v103
    v_and_b32 v103, 0xffff0000, v70
    v_add_f32 v2, v2, v89
    v_fmac_f32 v3, v103, v89
    v_mov_b32 v89, v103
    v_lshlrev_b32 v103, 16, v71
    v_add_f32 v2, v2, v90
    v_fmac_f32 v3, v103, v90
    v_mov_b32 v90, v103
    v_and_b32 v103, 0xffff0000, v71
    v_add_f32 v2, v2, v91
    v_fmac_f32 v3, v103, v91
    v_mov_b32 v91, v103
    v_lshlrev_b32 v103, 16, v72
    v_add_f32 v2, v2, v92
    v_fmac_f32 v3, v103, v92
    v_mov_b32 v92, v103
    v_and_b32 v103, 0xffff0000, v72
    v_add_f32 v2, v2, v93
    v_fmac_f32 v3, v103, v93
    v_mov_b32 v93, v103
    v_lshlrev_b32 v103, 16, v73
    v_add_f32 v2, v2, v94
    v_fmac_f32 v3, v103, v94
    v_mov_b32 v94, v103
    v_and_b32 v103, 0xffff0000, v73
    v_add_f32 v2, v2, v95
    v_fmac_f32 v3, v103, v95
    v_mov_b32 v95, v103
    v_lshlrev_b32 v103, 16, v74
    v_add_f32 v2, v2, v96
    v_fmac_f32 v3, v103, v96
    v_mov_b32 v96, v103
    v_and_b32 v103, 0xffff0000, v74
    v_add_f32 v2, v2, v97
    v_fmac_f32 v3, v103, v97
    v_mov_b32 v97, v103
    v_lshlrev_b32 v103, 16, v75
    v_add_f32 v2, v2, v98
    v_fmac_f32 v3, v103, v98
    v_mov_b32 v98, v103
    v_and_b32 v103, 0xffff0000, v75
    v_add_f32 v2, v2, v99
    v_fmac_f32 v3, v103, v99
    v_mov_b32 v99, v103
kms_rdn:
    v_mfma_f32_32x32x16_bf16 v[68:83], v[4:7], v[36:39], 0
    v_mfma_f32_32x32x16_bf16 v[68:83], v[8:11], v[40:43], v[68:83]
    v_mfma_f32_32x32x16_bf16 v[68:83], v[12:15], v[44:47], v[68:83]
    v_mfma_f32_32x32x16_bf16 v[68:83], v[16:19], v[48:51], v[68:83]
    v_mfma_f32_32x32x16_bf16 v[68:83], v[20:23], v[52:55], v[68:83]
    v_mfma_f32_32x32x16_bf16 v[68:83], v[24:27], v[56:59], v[68:83]
    v_mfma_f32_32x32x16_bf16 v[68:83], v[28:31], v[60:63], v[68:83]
    v_mfma_f32_32x32x16_bf16 v[68:83], v[32:35], v[64:67], v[68:83]
    s_lshl_b32 s15, s17, 10
    s_lshl_b32 s16, s18, 3
    s_add_u32 s15, s15, s16
    s_add_u32 s15, s15, 155648
    v_lshl_add_u32 v103, v100, 5, s15
    v_lshl_add_u32 v103, v101, 2, v103
    ds_write_b32 v103, v2
    ds_write_b32 v103, v3 offset:4096
    v_lshlrev_b32 v102, 1, v102
    v_add_u32 v102, 73728, v102
    s_cmp_lg_u32 s17, 0
    s_cbranch_scc1 kms_now
    s_mov_b32 exec_lo, 1
    s_mov_b32 exec_hi, 1
    ds_write_b128 v102, v[84:87] offset:512
    ds_write_b128 v102, v[88:91] offset:544
    ds_write_b128 v102, v[92:95] offset:576
    ds_write_b128 v102, v[96:99] offset:608
    s_mov_b64 exec, -1
kms_now:
    s_nop 7
    v_add_f32 v2, v68, v69
    v_add_f32 v2, v2, v70
    v_add_f32 v2, v2, v71
    v_add_f32 v2, v2, v72
    v_add_f32 v2, v2, v73
    v_add_f32 v2, v2, v74
    v_add_f32 v2, v2, v75
    v_add_f32 v2, v2, v76
    v_add_f32 v2, v2, v77
    v_add_f32 v2, v2, v78
    v_add_f32 v2, v2, v79
    v_add_f32 v2, v2, v80
    v_add_f32 v2, v2, v81
    v_add_f32 v2, v2, v82
    v_add_f32 v2, v2, v83
    s_lshl_b32 s15, s18, 10
    s_lshl_b32 s16, s17, 3
    s_add_u32 s15, s15, s16
    s_add_u32 s15, s15, 77824
    v_lshl_add_u32 v103, v100, 5, s15
    v_lshl_add_u32 v103, v101, 2, v103
    ds_write_b32 v103, v2
    s_mov_b32 s15, 155648
    s_cmp_ge_u32 s14, 4
    s_cselect_b32 s15, 69632, s15
    v_lshl_add_u32 v2, v0, 5, s15
    v_lshlrev_b32 v3, 2, v0
    v_add_u32 v3, 74752, v3
    s_waitcnt lgkmcnt(0)
    s_barrier
    s_cmp_ge_u32 s14, 6
    s_cbranch_scc1 kms_nosum
    ds_read_b128 v[4:7], v2
    ds_read_b128 v[8:11], v2 offset:16
    s_waitcnt lgkmcnt(0)
    v_add_f32 v4, v4, v5
    v_add_f32 v6, v6, v7
    v_add_f32 v8, v8, v9
    v_add_f32 v10, v10, v11
    v_add_f32 v4, v4, v6
    v_add_f32 v8, v8, v10
    v_add_f32 v4, v4, v8
    ds_write_b32 v3, v4
kms_nosum:
    s_lshl_b32 s15, s18, 7
    s_add_u32 s15, s15, 73728
    v_lshl_add_u32 v103, v100, 2, s15
    s_lshl_b32 s15, s17, 7
    s_add_u32 s15, s15, 73728
    v_lshl_add_u32 v102, v101, 4, s15
    v_lshlrev_b32 v3, 3, v1
    v_add_u32 v3, 73728, v3
    s_waitcnt lgkmcnt(0)
    s_barrier
    ds_read_b32 v2, v103 offset:2048
    ds_read_b64 v[38:39], v3 offset:1024
    s_cmp_eq_u32 s2, 161
    s_cbranch_scc1 kms_fw
    ds_read_b128 v[4:7], v102 offset:1024
    ds_read_b128 v[8:11], v102 offset:1056
    ds_read_b128 v[12:15], v102 offset:1088
    ds_read_b128 v[16:19], v102 offset:1120
    s_waitcnt lgkmcnt(4)
    v_add_f32 v38, v38, v39
    s_nop 1
    v_add_f32_dpp v38, v38, v38 row_shr:1 row_mask:0xf bank_mask:0xf
    s_nop 1
    v_add_f32_dpp v38, v38, v38 row_shr:2 row_mask:0xf bank_mask:0xf
    s_nop 1
    v_add_f32_dpp v38, v38, v38 row_shr:4 row_mask:0xf bank_mask:0xf
    s_nop 1
    v_add_f32_dpp v38, v38, v38 row_shr:8 row_mask:0xf bank_mask:0xf
    s_nop 1
    v_add_f32_dpp v38, v38, v38 row_bcast:15 row_mask:0xa bank_mask:0xf
    s_nop 1
    v_add_f32_dpp v38, v38, v38 row_bcast:31 row_mask:0xc bank_mask:0xf
    s_nop 0
    v_readlane_b32 s24, v38, 63
    v_mov_b32 v3, 0x3c000000
    v_mov_b32 v36, 0x3e0293ee
    v_fma_f32 v2, -v3, s24, v2
    v_mul_f32 v3, v3, v36
    v_mul_f32 v2, v2, v3
    s_waitcnt lgkmcnt(0)
    v_fma_f32 v4, v4, v3, v2
    v_fma_f32 v5, v5, v3, v2
    v_fma_f32 v6, v6, v3, v2
    v_fma_f32 v7, v7, v3, v2
    v_fma_f32 v8, v8, v3, v2
    v_fma_f32 v9, v9, v3, v2
    v_fma_f32 v10, v10, v3, v2
    v_fma_f32 v11, v11, v3, v2
    v_fma_f32 v12, v12, v3, v2
    v_fma_f32 v13, v13, v3, v2
    v_fma_f32 v14, v14, v3, v2
    v_fma_f32 v15, v15, v3, v2
    v_fma_f32 v16, v16, v3, v2
    v_fma_f32 v17, v17, v3, v2
    v_fma_f32 v18, v18, v3, v2
    v_fma_f32 v19, v19, v3, v2
    v_fma_f32 v68, v68, v36, -v4
    v_fma_f32 v69, v69, v36, -v5
    v_fma_f32 v70, v70, v36, -v6
    v_fma_f32 v71, v71, v36, -v7
    v_fma_f32 v72, v72, v36, -v8
    v_fma_f32 v73, v73, v36, -v9
    v_fma_f32 v74, v74, v36, -v10
    v_fma_f32 v75, v75, v36, -v11
    v_fma_f32 v76, v76, v36, -v12
    v_fma_f32 v77, v77, v36, -v13
    v_fma_f32 v78, v78, v36, -v14
    v_fma_f32 v79, v79, v36, -v15
    v_fma_f32 v80, v80, v36, -v16
    v_fma_f32 v81, v81, v36, -v17
    v_fma_f32 v82, v82, v36, -v18
    v_fma_f32 v83, v83, v36, -v19
    s_branch kms_fd
kms_fw:
    ds_read_b64 v[36:37], v3 offset:512
    ds_read_b64 v[40:41], v3 offset:1536
    s_waitcnt lgkmcnt(3)
    v_mul_f32 v2, 0x3c000000, v2
    v_sub_f32 v68, v68, v2
    v_sub_f32 v69, v69, v2
    v_sub_f32 v70, v70, v2
    v_sub_f32 v71, v71, v2
    v_sub_f32 v72, v72, v2
    v_sub_f32 v73, v73, v2
    v_sub_f32 v74, v74, v2
    v_sub_f32 v75, v75, v2
    v_sub_f32 v76, v76, v2
    v_sub_f32 v77, v77, v2
    v_sub_f32 v78, v78, v2
    v_sub_f32 v79, v79, v2
    v_sub_f32 v80, v80, v2
    v_sub_f32 v81, v81, v2
    v_sub_f32 v82, v82, v2
    v_sub_f32 v83, v83, v2
kms_fd:
    v_cvt_pk_bf16_f32 v84, v68, v69
    v_cvt_pk_bf16_f32 v85, v70, v71
    v_cvt_pk_bf16_f32 v86, v76, v77
    v_cvt_pk_bf16_f32 v87, v78, v79
    v_cvt_pk_bf16_f32 v88, v72, v73
    v_cvt_pk_bf16_f32 v89, v74, v75
    v_cvt_pk_bf16_f32 v90, v80, v81
    v_cvt_pk_bf16_f32 v91, v82, v83
    s_sub_u32 s15, s2, 160
    s_lshl_b32 s15, s15, 15
    s_lshl_b32 s16, s18, 13
    s_add_u32 s15, s15, s16
    s_lshl_b32 s16, s17, 10
    s_add_u32 s15, s15, s16
    s_add_u32 s15, s15, 167936
    s_add_u32 s20, s4, s15
    s_addc_u32 s21, s5, 0
    v_and_b32 v2, 15, v1
    v_lshlrev_b32 v2, 4, v2
    v_lshl_add_u32 v2, v101, 8, v2
    v_bfe_u32 v3, v1, 4, 1
    v_lshl_add_u32 v2, v3, 12, v2
    v_lshlrev_b32 v102, 4, v1
    global_store_dwordx4 v2, v[84:87], s[20:21] sc1
    global_store_dwordx4 v2, v[88:91], s[20:21] offset:512 sc1
    s_cmp_lg_u32 s2, 161
    s_cbranch_scc1 kms_late
    s_cmp_ge_u32 s14, 4
    s_cbranch_scc1 kms_late
    s_waitcnt lgkmcnt(0)
    v_add_f32 v36, v36, v37
    v_add_f32 v38, v38, v39
    v_add_f32 v40, v40, v41
    v_add_f32_dpp v36, v36, v36 row_shr:1 row_mask:0xf bank_mask:0xf
    v_add_f32_dpp v38, v38, v38 row_shr:1 row_mask:0xf bank_mask:0xf
    v_add_f32_dpp v40, v40, v40 row_shr:1 row_mask:0xf bank_mask:0xf
    v_add_f32_dpp v36, v36, v36 row_shr:2 row_mask:0xf bank_mask:0xf
    v_add_f32_dpp v38, v38, v38 row_shr:2 row_mask:0xf bank_mask:0xf
    v_add_f32_dpp v40, v40, v40 row_shr:2 row_mask:0xf bank_mask:0xf
    v_add_f32_dpp v36, v36, v36 row_shr:4 row_mask:0xf bank_mask:0xf
    v_add_f32_dpp v38, v38, v38 row_shr:4 row_mask:0xf bank_mask:0xf
    v_add_f32_dpp v40, v40, v40 row_shr:4 row_mask:0xf bank_mask:0xf
    v_add_f32_dpp v36, v36, v36 row_shr:8 row_mask:0xf bank_mask:0xf
    v_add_f32_dpp v38, v38, v38 row_shr:8 row_mask:0xf bank_mask:0xf
    v_add_f32_dpp v40, v40, v40 row_shr:8 row_mask:0xf bank_mask:0xf
    v_add_f32_dpp v36, v36, v36 row_bcast:15 row_mask:0xa bank_mask:0xf
    v_add_f32_dpp v38, v38, v38 row_bcast:15 row_mask:0xa bank_mask:0xf
    v_add_f32_dpp v40, v40, v40 row_bcast:15 row_mask:0xa bank_mask:0xf
    v_add_f32_dpp v36, v36, v36 row_bcast:31 row_mask:0xc bank_mask:0xf
    v_add_f32_dpp v38, v38, v38 row_bcast:31 row_mask:0xc bank_mask:0xf
    v_add_f32_dpp v40, v40, v40 row_bcast:31 row_mask:0xc bank_mask:0xf
    v_readlane_b32 s26, v36, 63
    v_readlane_b32 s24, v38, 63
    v_readlane_b32 s25, v40, 63
    v_and_b32 v2, 7, v1
    v_lshlrev_b32 v2, 1, v2
    v_mov_b32 v3, 0xe1e0
    v_bfe_u32 v2, v3, v2, 2
    v_lshlrev_b32 v3, 9, v2
    v_and_b32 v36, 48, v1
    v_add_u32 v3, v3, v36
    s_lshl_b32 s15, s14, 7
    s_add_u32 s15, s15, 73728
    v_add_u32 v3, s15, v3
    ds_read_b128 v[4:7], v3
    ds_read_b128 v[8:11], v3 offset:64
    v_mov_b32 v36, 1.0
    v_mov_b32 v37, 0
    v_mov_b32 v38, 0x3c000000
    v_cmp_eq_u32 vcc, 0, v2
    v_mul_f32 v39, s24, v38
    v_mul_f32 v39, v39, v38
    v_cndmask_b32 v37, v37, v38, vcc
    v_cmp_eq_u32 vcc, 2, v2
    v_sub_f32 v39, 0, v39
    v_mul_f32 v40, s25, v38
    v_cndmask_b32 v36, v36, v38, vcc
    v_cndmask_b32 v37, v37, v39, vcc
    v_cmp_eq_u32 vcc, 3, v2
    v_sub_f32 v40, 0, v40
    s_nop 0
    v_cndmask_b32 v37, v37, v40, vcc
    s_waitcnt lgkmcnt(0)
    v_fma_f32 v4, v4, v36, v37
    v_fma_f32 v5, v5, v36, v37
    v_fma_f32 v6, v6, v36, v37
    v_fma_f32 v7, v7, v36, v37
    v_fma_f32 v8, v8, v36, v37
    v_fma_f32 v9, v9, v36, v37
    v_fma_f32 v10, v10, v36, v37
    v_fma_f32 v11, v11, v36, v37
    v_cvt_pk_bf16_f32 v12, v4, v5
    v_cvt_pk_bf16_f32 v13, v6, v7
    v_cvt_pk_bf16_f32 v14, v8, v9
    v_cvt_pk_bf16_f32 v15, v10, v11
    s_lshl_b32 s15, s14, 10
    s_add_u32 s15, s15, 163840
    s_add_u32 s20, s4, s15
    s_addc_u32 s21, s5, 0
    global_store_dwordx4 v102, v[12:15], s[20:21] sc1
    v_mov_b32 v2, 233472
    v_mov_b32 v3, s26
    global_store_dword v2, v3, s[4:5] sc1
    s_branch kms_late
km_pick:
    v_subrev_u32 v114, s90, v112
    v_cmp_lt_u32 vcc, 1, v114
    s_and_b32 s79, s76, 7
    s_and_b32 s78, vcc_lo, 0xff
    s_bitcmp1_b32 s78, s79
    s_cbranch_scc1 km_cas
    s_cmp_lg_u32 s78, 0
    s_cbranch_scc1 km_try
    s_add_u32 s84, s84, 1
    s_add_u32 s78, s76, 8
    s_and_b32 s78, s78, 24
    s_andn2_b32 s76, s76, 24
    s_or_b32 s76, s76, s78
    s_and_b32 s78, s84, 3
    s_cselect_b32 s78, 0, 32
    s_add_u32 s76, s76, s78
    s_and_b32 s76, s76, 255
km_relook:
    s_lshr_b32 s78, s76, 3
    s_lshl_b32 s78, s78, 7
    s_add_u32 s78, s78, 258048
    v_and_b32 v113, 7, v1
    v_lshl_add_u32 v113, v113, 2, s78
    global_load_dword v112, v113, s[4:5] sc1
    s_waitcnt vmcnt(0)
    s_branch km_pick
km_try:
    s_mul_i32 s78, s78, 0x101
    s_and_b32 s79, s2, 7
    s_lshr_b32 s78, s78, s79
    s_ff1_i32_b32 s78, s78
    s_add_u32 s78, s78, s79
    s_and_b32 s79, s78, 7
    s_andn2_b32 s76, s76, 7
    s_or_b32 s76, s76, s79
km_cas:
    s_lshr_b32 s78, s76, 5
    s_cmp_lg_u32 s78, s77
    s_addc_u32 s78, s90, 0
    v_mov_b32 v114, s78
    v_mov_b32 v115, v112
    v_mov_b32 v116, v112
    s_lshl_b64 exec, 1, s79
    global_atomic_cmpswap v116, v113, v[114:115], s[4:5] sc0 sc1
    s_mov_b64 exec, -1
    s_add_u32 s82, s82, 4
    s_addc_u32 s83, s83, 0
    s_setpc_b64 s[82:83]
    km_ct:
    s_cmp_ge_u32 s14, 4
    s_cbranch_scc1 km_i2
    s_sub_u32 s78, s2, 162
    s_lshl_b32 s78, s78, 15
    s_add_u32 s78, s78, 131072
    v_lshl_add_u32 v16, v0, 7, s78
    global_load_dword v17, v16, s[4:5] sc1
    s_branch km_i2
km_rwa:
    s_sleep 2
    global_load_dword v112, v113, s[4:5] sc1
    s_waitcnt vmcnt(0)
    s_branch km_rqa
km_t1:
    s_lshl_b32 s78, s6, 13
    s_add_u32 s78, s78, 2101248
    v_lshl_add_u32 v112, v1, 4, s78
    v_mov_b32 v116, -1
    v_mov_b32 v117, -1
    v_mov_b32 v118, -1
    v_mov_b32 v119, -1
    global_store_dwordx4 v112, v[116:119], s[4:5] offset:-4096 sc1
    global_store_dwordx4 v112, v[116:119], s[4:5] offset:-3072 sc1
    global_store_dwordx4 v112, v[116:119], s[4:5] offset:-2048 sc1
    global_store_dwordx4 v112, v[116:119], s[4:5] offset:-1024 sc1
    global_store_dwordx4 v112, v[116:119], s[4:5] offset:0 sc1
    global_store_dwordx4 v112, v[116:119], s[4:5] offset:1024 sc1
    global_store_dwordx4 v112, v[116:119], s[4:5] offset:2048 sc1
    global_store_dwordx4 v112, v[116:119], s[4:5] offset:3072 sc1
    v_min_u32 v120, 39, v1
    v_mul_u32_u24 v120, 512, v120
    v_add_u32 v120, 131200, v120
km_ppa:
km_pia:
    global_load_dword v121, v120, s[4:5] offset:-128 sc1
    global_load_dword v122, v120, s[4:5] sc1
    global_load_dword v123, v120, s[4:5] offset:128 sc1
    global_load_dword v124, v120, s[4:5] offset:256 sc1
    s_waitcnt vmcnt(0)
    v_xor_b32 v121, s90, v121
    v_xor_b32 v122, s90, v122
    v_xor_b32 v123, s90, v123
    v_xor_b32 v124, s90, v124
    v_or3_b32 v121, v121, v122, v123
    v_or_b32 v121, v121, v124
    v_cmp_ne_u32 vcc, 0, v121
    s_cbranch_vccnz kms_appd
    v_mov_b32 v120, 42272
    v_mov_b32 v121, 1
    ds_write_b32 v120, v121
    s_branch kms_appd
km_rwb:
    s_sleep 2
    global_load_dword v112, v113, s[4:5] sc1
    s_waitcnt vmcnt(0)
    s_branch km_rqb
km_p0b:
    s_lshr_b32 s78, s76, 3
    s_mul_i32 s78, s78, 81920
    s_add_u32 s78, s78, 4194304
    s_add_u32 s68, s4, s78
    s_addc_u32 s69, s5, 0
    s_mov_b32 s70, 81920
    s_cmp_lg_u32 s14, 13
    s_cbranch_scc1 km_pdb
    s_and_b32 s78, s76, 7
    s_mul_i32 s78, s78, 10240
    s_add_u32 s78, s78, 2621440
    v_lshl_add_u32 v112, v1, 4, s78
    v_mov_b32 v116, -1
    v_mov_b32 v117, -1
    v_mov_b32 v118, -1
    v_mov_b32 v119, -1
    s_mov_b32 s79, 0
    s_lshl_b32 s78, s76, 4
    s_add_u32 s78, s78, 262156
    v_mov_b32 v114, s78
    v_mov_b32 v115, s90
    s_cmp_lg_u32 s85, 0
    s_cbranch_scc1 km_p0sb
km_p0fb:
    v_add_u32 v113, 2621440, v112
    global_store_dwordx4 v112, v[116:119], s[68:69]
    global_store_dwordx4 v113, v[116:119], s[68:69]
    v_add_u32 v112, 1024, v112
    s_add_u32 s79, s79, 1
    s_cmp_lt_u32 s79, 10
    s_cbranch_scc1 km_p0fb
    s_mov_b64 exec, 1
    s_waitcnt vmcnt(0)
    global_store_dword v114, v115, s[4:5]
    s_mov_b64 exec, -1
    s_branch km_p0rb
km_p0sb:
    v_add_u32 v113, 2621440, v112
    global_store_dwordx4 v112, v[116:119], s[68:69] sc1
    global_store_dwordx4 v113, v[116:119], s[68:69] sc1
    v_add_u32 v112, 1024, v112
    s_add_u32 s79, s79, 1
    s_cmp_lt_u32 s79, 10
    s_cbranch_scc1 km_p0sb
    s_mov_b64 exec, 1
    s_waitcnt vmcnt(0)
    global_store_dword v114, v115, s[4:5] sc1
    s_mov_b64 exec, -1
    s_branch km_p0rb
km_pdb:
    s_sub_u32 s82, s14, 14
    s_mov_b32 s83, 2
    s_mov_b32 s84, 20
    s_cmp_ge_u32 s2, 160
    s_cbranch_scc1 km_pk
    v_mov_b32 v120, 42272
    ds_read_b32 v120, v120
    s_waitcnt lgkmcnt(0)
    v_cmp_ne_u32 vcc, 0, v120
    s_cbranch_vccnz km_pjb
km_pk:
    s_sub_u32 s82, s14, 14
    v_min_u32 v120, 39, v1
    v_mul_u32_u24 v120, 512, v120
    v_add_u32 v120, 131200, v120
    s_cmp_lt_u32 s2, 162
    s_cbranch_scc1 km_pib
km_ppb:
    s_sleep 20
km_pib:
    global_load_dword v121, v120, s[4:5] offset:-128 sc1
    global_load_dword v122, v120, s[4:5] sc1
    global_load_dword v123, v120, s[4:5] offset:128 sc1
    global_load_dword v124, v120, s[4:5] offset:256 sc1
    s_waitcnt vmcnt(0)
    v_xor_b32 v121, s90, v121
    v_xor_b32 v122, s90, v122
    v_xor_b32 v123, s90, v123
    v_xor_b32 v124, s90, v124
    v_or3_b32 v121, v121, v122, v123
    v_or_b32 v121, v121, v124
    v_cmp_ne_u32 vcc, 0, v121
    s_cbranch_vccnz km_ppb
    s_cmp_lt_u32 s2, 162
    s_nop 0
km_pjb:
    v_lshlrev_b32 v112, 4, v1
km_sdb:
    s_lshl_b32 s78, s82, 12
    s_cmp_ge_u32 s82, 10
    s_cselect_b32 s79, 40960, 0
    s_add_u32 m0, s78, s79
    s_cmp_eq_u32 s82, 19
    buffer_load_dwordx4 v112, s[68:71], s78 offen offset:0 sc1 lds
    buffer_load_dwordx4 v112, s[68:71], s78 offen offset:1024 sc1 lds
    buffer_load_dwordx4 v112, s[68:71], s78 offen offset:2048 sc1 lds
    s_cbranch_scc1 km_p0rb
    buffer_load_dwordx4 v112, s[68:71], s78 offen offset:3072 sc1 lds
    s_add_u32 s82, s82, s83
    s_cmp_lt_u32 s82, s84
    s_cbranch_scc1 km_sdb
    s_branch km_p0rb
km_rww:
    s_sleep 2
    global_load_dword v112, v113, s[4:5] sc1
    s_waitcnt vmcnt(0)
    s_branch km_rqw
    km_again:
    s_lshl_b32 s12, s46, 13
    s_add_u32 s12, s12, 2101248
    s_add_u32 s22, s4, s12
    s_addc_u32 s23, s5, 0
    s_mov_b32 s28, 2
    s_branch km_relist
km_1_rs0:
    s_cmp_ge_u32 s11, 6
    s_cbranch_scc1 km_1_nors0
    global_store_dwordx2 v8, v[34:35], s[58:59] sc1
    global_store_dwordx2 v9, v[34:35], s[58:59] sc1
    s_branch km_1_nors0
km_1_half:
    ds_read_b64 v[26:27], v98 offset:0
    ds_read_b64 v[28:29], v99 offset:0
    ds_read_b64 v[30:31], v100 offset:0
    ds_read_b64 v[32:33], v101 offset:0
    s_branch km_1_go0
km_1_sp0:
    s_cmp_eq_u32 s38, 0
    s_cbranch_scc1 km_1_ovfret0
    s_mul_i32 s12, s47, 1280000
    s_add_u32 s12, s12, 50331648
    s_add_u32 s48, s4, s12
    s_addc_u32 s49, s5, 0
    s_mov_b32 s14, 0
km_1_ovfl0:
    s_lshl_b32 s12, s14, 2
    v_mov_b32 v24, s12
    global_load_dword v25, v24, s[48:49] sc1
    v_mov_b32 v24, 121088
    s_waitcnt vmcnt(0)
    v_readfirstlane_b32 s50, v25
    s_lshr_b32 s12, s50, 26
    s_and_b32 s50, s50, 0x3fff
    s_lshl_b32 s50, s50, 3
    s_lshr_b32 s13, s12, 5
    s_xor_b32 s13, s13, s10
    s_bitcmp1_b32 s13, 0
    s_cbranch_scc1 km_1_ovfn0
    s_mov_b32 m0, s12
    v_writelane_b32 v24, s50, m0
    ds_read_b64 v[26:27], v24 offset:0
    s_waitcnt lgkmcnt(0)
    v_mfma_f32_4x4x4_16b_bf16 v[18:21], v[4:5], v[26:27], v[18:21]
km_1_ovfn0:
    s_add_u32 s14, s14, 1
    s_cmp_lt_u32 s14, s38
    s_cbranch_scc1 km_1_ovfl0
km_1_ovfret0:
    v_add_u32 v24, s43, v8
    s_nop 4
    v_mov_b32 v26, v18
    v_mov_b32 v27, v19
    v_mov_b32 v28, v20
    v_mov_b32 v29, v21
    v_permlane32_swap_b32 v18, v26
    v_permlane32_swap_b32 v19, v27
    v_permlane32_swap_b32 v20, v28
    v_permlane32_swap_b32 v21, v29
    v_add_f32 v18, v18, v26
    v_add_f32 v19, v19, v27
    v_add_f32 v20, v20, v28
    v_add_f32 v21, v21, v29
    v_mul_f32 v18, v6, v18
    v_mul_f32 v19, v6, v19
    v_mul_f32 v20, v6, v20
    v_mul_f32 v21, v6, v21
    s_cmp_eq_u32 s11, 7
    s_cbranch_scc1 km_1_lastp0
    v_mul_f32 v26, v6, v18
    v_mul_f32 v27, v6, v19
    v_mul_f32 v28, v6, v20
    v_mul_f32 v29, v6, v21
    v_cvt_pk_bf16_f32 v22, v26, v27
    v_cvt_pk_bf16_f32 v23, v28, v29
    v_min_u32 v22, -2, v22
    s_cmp_lg_u32 s42, 0
    s_waitcnt vmcnt(0)
    s_cbranch_scc1 km_1_gs0
    global_store_dwordx2 v8, v[22:23], s[16:17]
    s_branch km_1_pub0
km_1_gs0:
    global_store_dwordx2 v8, v[22:23], s[16:17] sc1
    s_branch km_1_pub0
km_1_lastp0:
    v_cvt_pk_bf16_f32 v12, v18, v19
    v_cvt_pk_bf16_f32 v13, v20, v21
    global_store_dwordx4 v0, v[10:13], s[22:23] sc1
    v_mov_b64 v[18:19], 0
    v_mov_b64 v[20:21], 0
    s_branch km_1_full
km_1_rs1:
    s_cmp_ge_u32 s11, 6
    s_cbranch_scc1 km_1_nors1
    global_store_dwordx2 v9, v[34:35], s[58:59] sc1
    s_branch km_1_nors1
km_1_sp1:
    s_cmp_eq_u32 s34, 0
    s_cbranch_scc1 km_1_ovfret1
    s_mul_i32 s12, s46, 1280000
    s_add_u32 s12, s12, 50331648
    s_add_u32 s48, s4, s12
    s_addc_u32 s49, s5, 0
    s_mov_b32 s14, 0
km_1_ovfl1:
    s_lshl_b32 s12, s14, 2
    v_mov_b32 v24, s12
    global_load_dword v25, v24, s[48:49] sc1
    v_mov_b32 v24, 121088
    s_waitcnt vmcnt(0)
    v_readfirstlane_b32 s50, v25
    s_lshr_b32 s12, s50, 26
    s_and_b32 s50, s50, 0x3fff
    s_lshl_b32 s50, s50, 3
    s_mov_b32 m0, s12
    v_writelane_b32 v24, s50, m0
    ds_read_b64 v[26:27], v24 offset:0
    s_waitcnt lgkmcnt(0)
    v_mfma_f32_4x4x4_16b_bf16 v[18:21], v[4:5], v[26:27], v[18:21]
km_1_ovfn1:
    s_add_u32 s14, s14, 1
    s_cmp_lt_u32 s14, s34
    s_cbranch_scc1 km_1_ovfl1
km_1_ovfret1:
    v_add_u32 v24, s43, v9
    s_nop 4
    v_mul_f32 v18, v7, v18
    v_mul_f32 v19, v7, v19
    v_mul_f32 v20, v7, v20
    v_mul_f32 v21, v7, v21
    s_cmp_eq_u32 s11, 7
    s_cbranch_scc1 km_1_lastp1
    v_mul_f32 v26, v7, v18
    v_mul_f32 v27, v7, v19
    v_mul_f32 v28, v7, v20
    v_mul_f32 v29, v7, v21
    v_cvt_pk_bf16_f32 v22, v26, v27
    v_cvt_pk_bf16_f32 v23, v28, v29
    v_min_u32 v22, -2, v22
    s_cmp_lg_u32 s42, 0
    s_waitcnt vmcnt(0)
    s_cbranch_scc1 km_1_gs1
    global_store_dwordx2 v9, v[22:23], s[16:17]
    s_branch km_1_pub1
km_1_gs1:
    global_store_dwordx2 v9, v[22:23], s[16:17] sc1
    s_branch km_1_pub1
km_1_lastp1:
    v_cvt_pk_bf16_f32 v16, v18, v19
    v_cvt_pk_bf16_f32 v17, v20, v21
    global_store_dwordx4 v2, v[14:17], s[22:23] sc1
    s_branch km_done
km_1_dly:
    s_cmp_eq_u32 s73, 0
    s_cbranch_scc1 km_1_fd0
    s_branch km_1_again0
km_1_fd0:
    s_waitcnt vmcnt(0) lgkmcnt(0)
    s_branch km_1_fdone
km_1_more:
    s_cmp_eq_u32 s73, 2
    s_cbranch_scc1 km_1_fetch1
    s_branch km_1_atk
km_1_again0:
    s_cmp_ge_u32 s10, 4
    s_cbranch_scc1 km_1_fetch0
    s_sleep 6
    s_branch km_1_fetch0
km_1_fetch1:
    s_add_u32 m0, s86, 40960
    v_add_u32 v24, s86, v1
    buffer_load_dwordx4 v1, s[16:19], s70 offen offset:0 sc1 lds
    buffer_load_dwordx4 v1, s[16:19], s70 offen offset:1024 sc1 lds
    s_add_u32 m0, s87, 40960
    v_add_u32 v25, s87, v1
    buffer_load_dwordx4 v1, s[16:19], s71 offen offset:0 sc1 lds
    buffer_load_dwordx4 v1, s[16:19], s71 offen offset:1024 sc1 lds
    s_waitcnt vmcnt(3)
    ds_read_b128 v[26:29], v24 offset:40960
    s_waitcnt vmcnt(2)
    ds_read_b128 v[30:33], v24 offset:41984
    s_waitcnt lgkmcnt(1)
    v_max_u32 v36, v26, v28
    s_waitcnt vmcnt(1)
    ds_read_b128 v[26:29], v25 offset:40960
    s_waitcnt lgkmcnt(1)
    v_max3_u32 v36, v36, v30, v32
    s_waitcnt vmcnt(0)
    ds_read_b128 v[30:33], v25 offset:41984
    s_waitcnt lgkmcnt(1)
    v_max3_u32 v36, v36, v26, v28
    s_waitcnt lgkmcnt(0)
    v_max3_u32 v36, v36, v30, v32
    v_cmp_eq_u32 vcc, -1, v36
    s_cbranch_vccnz km_1_again1
km_1_atk:
    s_branch km_1_fdone
km_1_again1:
    s_cmp_ge_u32 s10, 4
    s_cbranch_scc1 km_1_fetch1
    s_sleep 2
    s_branch km_1_fetch1
km_0_rs0:
    s_cmp_ge_u32 s11, 6
    s_cbranch_scc1 km_0_nors0
    global_store_dwordx2 v8, v[34:35], s[58:59] sc1
    global_store_dwordx2 v9, v[34:35], s[58:59] sc1
    s_branch km_0_nors0
km_0_sp0:
    s_cmp_eq_u32 s38, 0
    s_cbranch_scc1 km_0_ovfret0
    s_mul_i32 s12, s47, 1280000
    s_add_u32 s12, s12, 50331648
    s_add_u32 s48, s4, s12
    s_addc_u32 s49, s5, 0
    s_mov_b32 s14, 0
km_0_ovfl0:
    s_lshl_b32 s12, s14, 2
    v_mov_b32 v24, s12
    global_load_dword v25, v24, s[48:49] sc1
    v_mov_b32 v24, 121088
    s_waitcnt vmcnt(0)
    v_readfirstlane_b32 s50, v25
    s_lshr_b32 s12, s50, 26
    s_and_b32 s50, s50, 0x3fff
    s_lshl_b32 s50, s50, 3
    s_lshr_b32 s13, s12, 5
    s_xor_b32 s13, s13, s10
    s_bitcmp1_b32 s13, 0
    s_cbranch_scc1 km_0_ovfn0
    s_mov_b32 m0, s12
    v_writelane_b32 v24, s50, m0
    ds_read_b64 v[26:27], v24 offset:40960
    s_waitcnt lgkmcnt(0)
    v_mfma_f32_4x4x4_16b_bf16 v[18:21], v[4:5], v[26:27], v[18:21]
km_0_ovfn0:
    s_add_u32 s14, s14, 1
    s_cmp_lt_u32 s14, s38
    s_cbranch_scc1 km_0_ovfl0
km_0_ovfret0:
    v_add_u32 v24, s43, v8
    s_nop 4
    v_mov_b32 v26, v18
    v_mov_b32 v27, v19
    v_mov_b32 v28, v20
    v_mov_b32 v29, v21
    v_permlane32_swap_b32 v18, v26
    v_permlane32_swap_b32 v19, v27
    v_permlane32_swap_b32 v20, v28
    v_permlane32_swap_b32 v21, v29
    v_add_f32 v18, v18, v26
    v_add_f32 v19, v19, v27
    v_add_f32 v20, v20, v28
    v_add_f32 v21, v21, v29
    v_mul_f32 v18, v6, v18
    v_mul_f32 v19, v6, v19
    v_mul_f32 v20, v6, v20
    v_mul_f32 v21, v6, v21
    v_mul_f32 v26, v6, v18
    v_mul_f32 v27, v6, v19
    v_mul_f32 v28, v6, v20
    v_mul_f32 v29, v6, v21
    v_cvt_pk_bf16_f32 v22, v26, v27
    v_cvt_pk_bf16_f32 v23, v28, v29
    v_min_u32 v22, -2, v22
    s_cmp_lg_u32 s42, 0
    s_waitcnt vmcnt(0)
    s_cbranch_scc1 km_0_gs0
    global_store_dwordx2 v8, v[22:23], s[16:17]
    s_branch km_0_pub0
km_0_gs0:
    global_store_dwordx2 v8, v[22:23], s[16:17] sc1
    s_branch km_0_pub0
km_0_rs1:
    s_cmp_ge_u32 s11, 6
    s_cbranch_scc1 km_0_nors1
    global_store_dwordx2 v9, v[34:35], s[58:59] sc1
    s_branch km_0_nors1
km_0_sp1:
    s_cmp_eq_u32 s34, 0
    s_cbranch_scc1 km_0_ovfret1
    s_mul_i32 s12, s46, 1280000
    s_add_u32 s12, s12, 50331648
    s_add_u32 s48, s4, s12
    s_addc_u32 s49, s5, 0
    s_mov_b32 s14, 0
km_0_ovfl1:
    s_lshl_b32 s12, s14, 2
    v_mov_b32 v24, s12
    global_load_dword v25, v24, s[48:49] sc1
    v_mov_b32 v24, 121088
    s_waitcnt vmcnt(0)
    v_readfirstlane_b32 s50, v25
    s_lshr_b32 s12, s50, 26
    s_and_b32 s50, s50, 0x3fff
    s_lshl_b32 s50, s50, 3
    s_mov_b32 m0, s12
    v_writelane_b32 v24, s50, m0
    ds_read_b64 v[26:27], v24 offset:40960
    s_waitcnt lgkmcnt(0)
    v_mfma_f32_4x4x4_16b_bf16 v[18:21], v[4:5], v[26:27], v[18:21]
km_0_ovfn1:
    s_add_u32 s14, s14, 1
    s_cmp_lt_u32 s14, s34
    s_cbranch_scc1 km_0_ovfl1
km_0_ovfret1:
    v_add_u32 v24, s43, v9
    s_nop 4
    v_mul_f32 v18, v7, v18
    v_mul_f32 v19, v7, v19
    v_mul_f32 v20, v7, v20
    v_mul_f32 v21, v7, v21
    v_mul_f32 v26, v7, v18
    v_mul_f32 v27, v7, v19
    v_mul_f32 v28, v7, v20
    v_mul_f32 v29, v7, v21
    v_cvt_pk_bf16_f32 v22, v26, v27
    v_cvt_pk_bf16_f32 v23, v28, v29
    v_min_u32 v22, -2, v22
    s_cmp_lg_u32 s42, 0
    s_waitcnt vmcnt(0)
    s_cbranch_scc1 km_0_gs1
    global_store_dwordx2 v9, v[22:23], s[16:17]
    s_branch km_0_pub1
km_0_gs1:
    global_store_dwordx2 v9, v[22:23], s[16:17] sc1
    s_branch km_0_pub1
km_0_dly:
    s_cmp_eq_u32 s73, 0
    s_cbranch_scc1 km_0_fd0
    s_branch km_0_again0
km_0_fd0:
    s_waitcnt vmcnt(0) lgkmcnt(0)
    s_branch km_0_fdone
km_0_more:
    s_cmp_eq_u32 s73, 2
    s_cbranch_scc1 km_0_fetch1
    s_branch km_0_atk
km_0_again0:
    s_cmp_ge_u32 s10, 4
    s_cbranch_scc1 km_0_fetch0
    s_sleep 6
    s_branch km_0_fetch0
km_0_fetch1:
    s_add_u32 m0, s86, 0
    v_add_u32 v24, s86, v1
    buffer_load_dwordx4 v1, s[16:19], s70 offen offset:0 sc1 lds
    buffer_load_dwordx4 v1, s[16:19], s70 offen offset:1024 sc1 lds
    s_add_u32 m0, s87, 0
    v_add_u32 v25, s87, v1
    buffer_load_dwordx4 v1, s[16:19], s71 offen offset:0 sc1 lds
    buffer_load_dwordx4 v1, s[16:19], s71 offen offset:1024 sc1 lds
    s_waitcnt vmcnt(3)
    ds_read_b128 v[26:29], v24 offset:0
    s_waitcnt vmcnt(2)
    ds_read_b128 v[30:33], v24 offset:1024
    s_waitcnt lgkmcnt(1)
    v_max_u32 v36, v26, v28
    s_waitcnt vmcnt(1)
    ds_read_b128 v[26:29], v25 offset:0
    s_waitcnt lgkmcnt(1)
    v_max3_u32 v36, v36, v30, v32
    s_waitcnt vmcnt(0)
    ds_read_b128 v[30:33], v25 offset:1024
    s_waitcnt lgkmcnt(1)
    v_max3_u32 v36, v36, v26, v28
    s_waitcnt lgkmcnt(0)
    v_max3_u32 v36, v36, v30, v32
    v_cmp_eq_u32 vcc, -1, v36
    s_cbranch_vccnz km_0_again1
km_0_atk:
    s_branch km_0_fdone
km_0_again1:
    s_cmp_ge_u32 s10, 4
    s_cbranch_scc1 km_0_fetch1
    s_sleep 2
    s_branch km_0_fetch1
code_end:
.section .rodata,"a"
.p2align 6
.amdhsa_kernel gather_scatter__hybrid_graph_tf_nagphormer__graph_kernel
  .amdhsa_next_free_vgpr 128
  .amdhsa_next_free_sgpr 92
  .amdhsa_accum_offset 128
  .amdhsa_group_segment_fixed_size 0
  .amdhsa_kernarg_size 96
  .amdhsa_user_sgpr_count 2
  .amdhsa_user_sgpr_kernarg_segment_ptr 1
  .amdhsa_system_sgpr_workgroup_id_x 1
  .amdhsa_float_denorm_mode_32 3
.end_amdhsa_kernel
```
